```python
import torch

def _softmax(x, axis=-1):
    return torch.softmax(x, dim=axis)
def _gelu(x):
    return torch.nn.functional.gelu(x, approximate="tanh")
def _silu(x):
    return torch.nn.functional.silu(x)
def _sigmoid(x):
    return torch.sigmoid(x)
def _layernorm(x, axis=-1, eps=1e-5):
    m = x.mean(dim=axis, keepdim=True)
    v = x.var(dim=axis, keepdim=True, unbiased=False)
    return (x - m) / torch.sqrt(v + eps)
def _scatter_add(tgt, idx, src, axis=0):
    return tgt.clone().index_add_(axis, idx, src)
def _segment_sum(src, seg, n):
    out = torch.zeros((n,) + src.shape[1:], dtype=src.dtype)
    return out.index_add_(0, seg, src)
def _pad(x, pw):
    flat = tuple(v for pair in reversed(pw) for v in pair)
    return torch.nn.functional.pad(x, flat)

kernel_name = 'recurrent_scan__ssm_conv_s5__dense_activation_squared_relu__prompt'

def setup_inputs():

    _w = (lambda a: (lambda t: t.to(torch.bfloat16) if t.is_floating_point() else t)(torch.as_tensor(a)))
    def _A_setup():
        B, S, D = 1, 2048, 640
        P = D
        Lambda_re = -0.5 * (lambda _x: torch.exp(torch.as_tensor(_x)))((lambda *s: torch.randn(*s, dtype=torch.bfloat16) * 0.2)(P))
        Lambda_im = (lambda *s: torch.randn(*s, dtype=torch.bfloat16) * 0.4)(P) * 1.0
        B_re = (lambda *s: torch.randn(*s, dtype=torch.bfloat16) * 0.2)(P, D) * (D ** -0.5)
        B_im = (lambda *s: torch.randn(*s, dtype=torch.bfloat16) * 0.2)(P, D) * (D ** -0.5)
        C_re = (lambda *s: torch.randn(*s, dtype=torch.bfloat16) * 0.2)(D, P) * (P ** -0.5)
        C_im = (lambda *s: torch.randn(*s, dtype=torch.bfloat16) * 0.2)(D, P) * (P ** -0.5)
        log_dt = (lambda *s: torch.randn(*s, dtype=torch.bfloat16) * 0.2)(P) * 0.3 - 2.0
        Dskip = (lambda *s: torch.randn(*s, dtype=torch.bfloat16) * 0.05)(D)
        return {
            "x": _w((lambda *s: torch.randn(*s, dtype=torch.bfloat16) * 0.05)(B, S, D)),
            "Lambda_re": _w(Lambda_re),
            "Lambda_im": _w(Lambda_im),
            "B_re": _w(B_re),
            "B_im": _w(B_im),
            "C_re": _w(C_re),
            "C_im": _w(C_im),
            "log_dt": _w(log_dt),
            "Dskip": _w(Dskip),
        }
    _A_in = _A_setup()

    def _B_setup():
        B, S, D, F = 1, 2048, 640, 1536
        return {
            "x": _w((lambda *s: torch.randn(*s, dtype=torch.bfloat16) * 0.05)(B, S, D)),
            "w1": _w((lambda *s: torch.randn(*s, dtype=torch.bfloat16) * 0.05)(D, F)),
            "b1": _w((lambda *s: torch.randn(*s, dtype=torch.bfloat16) * 0.4)(F)),
            "w2": _w((lambda *s: torch.randn(*s, dtype=torch.bfloat16) * 0.05)(F, D)),
            "b2": _w((lambda *s: torch.randn(*s, dtype=torch.bfloat16) * 1.6)(D)),
        }
    _B_in = _B_setup()

    return {
        "A_x": _A_in["x"],
        "A_Lambda_re": _A_in["Lambda_re"],
        "A_Lambda_im": _A_in["Lambda_im"],
        "A_B_re": _A_in["B_re"],
        "A_B_im": _A_in["B_im"],
        "A_C_re": _A_in["C_re"],
        "A_C_im": _A_in["C_im"],
        "A_log_dt": _A_in["log_dt"],
        "A_Dskip": _A_in["Dskip"],
        "B_x": _B_in["x"],
        "B_w1": _B_in["w1"],
        "B_b1": _B_in["b1"],
        "B_w2": _B_in["w2"],
        "B_b2": _B_in["b2"],
    }

def reference(A_x, A_Lambda_re, A_Lambda_im, A_B_re, A_B_im, A_C_re, A_C_im, A_log_dt, A_Dskip, B_x, B_w1, B_b1, B_w2, B_b2):
    def _A_ref(x, Lambda_re, Lambda_im, B_re, B_im, C_re, C_im, log_dt, Dskip):
        Bsz, L, H = x.shape
        Lam = Lambda_re + 1j * Lambda_im
        Bmat = B_re + 1j * B_im
        Cmat = C_re + 1j * C_im
        dt = torch.exp(log_dt)
        Lam_bar = torch.exp(dt * Lam)
        B_bar = ((Lam_bar - 1.0) / Lam)[:, None] * Bmat
        Bu = torch.einsum("bld,pd->blp", x + 0j, B_bar)
        h = torch.zeros_like(Bu[:, 0, :])
        hs = []
        for t in range(L):
            h = Lam_bar[None, :] * h + Bu[:, t, :]
            hs.append(h)
        hseq = torch.stack(hs, 1)
        y = 2.0 * torch.einsum("blp,dp->bld", hseq, Cmat).real + x * Dskip[None, None, :]
        return y

    def _B_ref(x, w1, b1, w2, b2):
        h = torch.einsum("bsd,df->bsf", x, w1) + b1
        zero = torch.zeros_like(h)
        r = torch.where(h > zero, h, zero)
        h = r * r
        out = torch.einsum("bsf,fd->bsd", h, w2) + b2
        return out

    x = A_x
    xn = _layernorm(x, axis=-1)
    s = _A_ref(xn, A_Lambda_re, A_Lambda_im, A_B_re, A_B_im, A_C_re, A_C_im, A_log_dt, A_Dskip)
    g = _silu(_B_ref(xn, B_w1, B_b1, B_w2, B_b2))
    return x + s * g
```

```asm
; @launch grid=(256,1,1) block=(768,1,1) lds=163840
.amdgcn_target "amdgcn-amd-amdhsa--gfx950"
.text
.globl recurrent_scan__ssm_conv_s5__dense_activation_squared_relu__prompt_kernel
.p2align 8
.type recurrent_scan__ssm_conv_s5__dense_activation_squared_relu__prompt_kernel,@function
recurrent_scan__ssm_conv_s5__dense_activation_squared_relu__prompt_kernel:
s_cmp_ge_u32 s2, 256
s_cbranch_scc1 L_END
s_load_dwordx16 s[36:51], s[0:1], 0
s_load_dwordx16 s[52:67], s[0:1], 64
s_load_dwordx2 s[68:69], s[0:1], 128
v_lshrrev_b32 v1, 6, v0
v_and_b32 v0, 63, v0
v_readfirstlane_b32 s3, v1
s_and_b32 s4, s2, 1
s_lshr_b32 s70, s2, 1
s_and_b32 s70, s70, 3
s_lshr_b32 s71, s2, 3
s_lshr_b32 s72, s71, 3
s_and_b32 s6, s71, 7
s_lshl_b32 s5, s70, 2
s_add_u32 s5, s5, s72
s_lshr_b32 s9, s6, 2
s_and_b32 s10, s6, 3
s_and_b32 s7, s3, 3
s_lshr_b32 s8, s3, 2
s_waitcnt lgkmcnt(0)
s_mov_b32 s12, s68
s_mov_b32 s13, s69
s_mov_b32 s14, 268435456
s_mov_b32 s15, 0x20000
s_mov_b32 s16, s36
s_mov_b32 s17, s37
s_mov_b32 s18, 2621440
s_mov_b32 s19, 0x20000
s_cmp_ge_u32 s3, 8
s_cbranch_scc1 L_LOADER
buffer_load_dword v3, off, s[12:15], 0 sc1
v_lshlrev_b32 v1, 4, v0
v_lshlrev_b32 v2, 2, v0
v_add_u32 v2, 1024, v2
s_lshl_b32 s70, s4, 3
s_add_u32 s70, s70, s6
s_lshl_b32 s70, s70, 3
s_add_u32 s70, s70, s3
s_lshl_b32 s71, s5, 7
s_add_u32 s74, s70, s71
s_mul_i32 s71, s74, 1280
buffer_load_dwordx4 v[4:7], v1, s[16:19], s71 offen
buffer_load_dword v8, v2, s[16:19], s71 offen
s_cmp_eq_u32 s4, 1
s_cbranch_scc1 L_CG
s_mul_i32 s86, s5, 10
s_add_u32 s86, s86, s3
s_cmp_ge_u32 s86, 80
s_cselect_b32 s70, 1, 0
s_cselect_b64 s[28:29], s[44:45], s[42:43]
s_mov_b32 s30, 819200
s_mov_b32 s31, 0x20000
s_mul_i32 s71, s70, 80
s_sub_u32 s86, s86, s71
s_mul_i32 s71, s6, 80
s_add_u32 s86, s86, s71
s_mul_i32 s71, s86, 1280
buffer_load_dwordx4 v[24:27], v1, s[28:31], s71 offen
buffer_load_dword v28, v2, s[28:31], s71 offen
s_mul_i32 s70, s70, 640
s_add_u32 s86, s86, s70
s_cmp_ge_u32 s3, 2
s_cbranch_scc1 L_S_NOROW2
s_mul_i32 s87, s5, 10
s_add_u32 s87, s87, s3
s_add_u32 s87, s87, 8
s_cmp_ge_u32 s87, 80
s_cselect_b32 s70, 1, 0
s_cselect_b64 s[28:29], s[44:45], s[42:43]
s_mov_b32 s30, 819200
s_mov_b32 s31, 0x20000
s_mul_i32 s71, s70, 80
s_sub_u32 s87, s87, s71
s_mul_i32 s71, s6, 80
s_add_u32 s87, s87, s71
s_mul_i32 s71, s87, 1280
buffer_load_dwordx4 v[30:33], v1, s[28:31], s71 offen
buffer_load_dword v34, v2, s[28:31], s71 offen
s_mul_i32 s70, s70, 640
s_add_u32 s87, s87, s70
L_S_NOROW2:
s_waitcnt vmcnt(0)
v_readfirstlane_b32 s11, v3
s_mul_i32 s11, s11, 1664525
s_add_u32 s11, s11, 1013904223
s_mov_b32 s70, 0x3f803f80
v_mov_b32 v14, 0
v_dot2_f32_bf16 v14, v4, s70, v14
s_nop 2
v_dot2_f32_bf16 v14, v5, s70, v14
s_nop 2
v_dot2_f32_bf16 v14, v6, s70, v14
s_nop 2
v_dot2_f32_bf16 v14, v7, s70, v14
s_nop 2
v_dot2_f32_bf16 v14, v8, s70, v14
s_nop 2
v_add_f32_dpp v14, v14, v14 row_shr:1 row_mask:0xf bank_mask:0xf bound_ctrl:1
s_nop 1
v_add_f32_dpp v14, v14, v14 row_shr:2 row_mask:0xf bank_mask:0xf bound_ctrl:1
s_nop 1
v_add_f32_dpp v14, v14, v14 row_shr:4 row_mask:0xf bank_mask:0xf bound_ctrl:1
s_nop 1
v_add_f32_dpp v14, v14, v14 row_shr:8 row_mask:0xf bank_mask:0xf bound_ctrl:1
s_nop 1
v_add_f32_dpp v14, v14, v14 row_bcast:15 row_mask:0xa bank_mask:0xf
s_nop 1
v_add_f32_dpp v14, v14, v14 row_bcast:31 row_mask:0xc bank_mask:0xf
s_nop 0
v_readlane_b32 s71, v14, 63
v_mov_b32 v15, 0x3acccccd
s_nop 0
v_mul_f32 v14, s71, v15
v_mov_b32 v15, 0
v_lshlrev_b32 v16, 16, v4
v_and_b32 v17, 0xffff0000, v4
v_sub_f32 v16, v16, v14
v_sub_f32 v17, v17, v14
v_fmac_f32 v15, v16, v16
v_fmac_f32 v15, v17, v17
v_lshlrev_b32 v16, 16, v5
v_and_b32 v17, 0xffff0000, v5
v_sub_f32 v16, v16, v14
v_sub_f32 v17, v17, v14
v_fmac_f32 v15, v16, v16
v_fmac_f32 v15, v17, v17
v_lshlrev_b32 v16, 16, v6
v_and_b32 v17, 0xffff0000, v6
v_sub_f32 v16, v16, v14
v_sub_f32 v17, v17, v14
v_fmac_f32 v15, v16, v16
v_fmac_f32 v15, v17, v17
v_lshlrev_b32 v16, 16, v7
v_and_b32 v17, 0xffff0000, v7
v_sub_f32 v16, v16, v14
v_sub_f32 v17, v17, v14
v_fmac_f32 v15, v16, v16
v_fmac_f32 v15, v17, v17
v_lshlrev_b32 v16, 16, v8
v_and_b32 v17, 0xffff0000, v8
v_sub_f32 v16, v16, v14
v_sub_f32 v17, v17, v14
v_fmac_f32 v15, v16, v16
v_fmac_f32 v15, v17, v17
s_nop 1
v_add_f32_dpp v15, v15, v15 row_shr:1 row_mask:0xf bank_mask:0xf bound_ctrl:1
s_nop 1
v_add_f32_dpp v15, v15, v15 row_shr:2 row_mask:0xf bank_mask:0xf bound_ctrl:1
s_nop 1
v_add_f32_dpp v15, v15, v15 row_shr:4 row_mask:0xf bank_mask:0xf bound_ctrl:1
s_nop 1
v_add_f32_dpp v15, v15, v15 row_shr:8 row_mask:0xf bank_mask:0xf bound_ctrl:1
s_nop 1
v_add_f32_dpp v15, v15, v15 row_bcast:15 row_mask:0xa bank_mask:0xf
s_nop 1
v_add_f32_dpp v15, v15, v15 row_bcast:31 row_mask:0xc bank_mask:0xf
s_nop 0
v_readlane_b32 s71, v15, 63
v_mov_b32 v15, 0x3acccccd
v_mov_b32 v16, 0x3727c5ac
v_fma_f32 v15, s71, v15, v16
v_rsq_f32 v15, v15
v_mov_b32 v16, v14
v_mov_b32 v17, s11
v_mov_b32 v18, v15
v_mov_b32 v19, s11
s_lshl_b32 s71, s74, 4
s_add_u32 s71, s71, 8192
s_mov_b64 exec, 1
buffer_store_dwordx4 v[16:19], off, s[12:15], s71 sc1
s_mov_b64 exec, -1
s_mov_b32 s70, 0x3f803f80
v_mov_b32 v14, 0
v_dot2_f32_bf16 v14, v24, s70, v14
s_nop 2
v_dot2_f32_bf16 v14, v25, s70, v14
s_nop 2
v_dot2_f32_bf16 v14, v26, s70, v14
s_nop 2
v_dot2_f32_bf16 v14, v27, s70, v14
s_nop 2
v_dot2_f32_bf16 v14, v28, s70, v14
s_nop 2
v_add_f32_dpp v14, v14, v14 row_shr:1 row_mask:0xf bank_mask:0xf bound_ctrl:1
s_nop 1
v_add_f32_dpp v14, v14, v14 row_shr:2 row_mask:0xf bank_mask:0xf bound_ctrl:1
s_nop 1
v_add_f32_dpp v14, v14, v14 row_shr:4 row_mask:0xf bank_mask:0xf bound_ctrl:1
s_nop 1
v_add_f32_dpp v14, v14, v14 row_shr:8 row_mask:0xf bank_mask:0xf bound_ctrl:1
s_nop 1
v_add_f32_dpp v14, v14, v14 row_bcast:15 row_mask:0xa bank_mask:0xf
s_nop 1
v_add_f32_dpp v14, v14, v14 row_bcast:31 row_mask:0xc bank_mask:0xf
s_nop 0
v_readlane_b32 s71, v14, 63
s_lshl_b32 s72, s86, 3
s_add_u32 s72, s72, 40960
v_mov_b32 v14, s71
v_mov_b32 v15, s11
s_mov_b64 exec, 1
buffer_store_dwordx2 v[14:15], off, s[12:15], s72 sc1
s_mov_b64 exec, -1
s_cmp_ge_u32 s3, 2
s_cbranch_scc1 L_S_NOROW2b
v_mov_b32 v14, 0
v_dot2_f32_bf16 v14, v30, s70, v14
s_nop 2
v_dot2_f32_bf16 v14, v31, s70, v14
s_nop 2
v_dot2_f32_bf16 v14, v32, s70, v14
s_nop 2
v_dot2_f32_bf16 v14, v33, s70, v14
s_nop 2
v_dot2_f32_bf16 v14, v34, s70, v14
s_nop 2
v_add_f32_dpp v14, v14, v14 row_shr:1 row_mask:0xf bank_mask:0xf bound_ctrl:1
s_nop 1
v_add_f32_dpp v14, v14, v14 row_shr:2 row_mask:0xf bank_mask:0xf bound_ctrl:1
s_nop 1
v_add_f32_dpp v14, v14, v14 row_shr:4 row_mask:0xf bank_mask:0xf bound_ctrl:1
s_nop 1
v_add_f32_dpp v14, v14, v14 row_shr:8 row_mask:0xf bank_mask:0xf bound_ctrl:1
s_nop 1
v_add_f32_dpp v14, v14, v14 row_bcast:15 row_mask:0xa bank_mask:0xf
s_nop 1
v_add_f32_dpp v14, v14, v14 row_bcast:31 row_mask:0xc bank_mask:0xf
s_nop 0
v_readlane_b32 s71, v14, 63
s_lshl_b32 s72, s87, 3
s_add_u32 s72, s72, 40960
v_mov_b32 v14, s71
v_mov_b32 v15, s11
s_mov_b64 exec, 1
buffer_store_dwordx2 v[14:15], off, s[12:15], s72 sc1
s_mov_b64 exec, -1
L_S_NOROW2b:
s_cmp_lg_u32 s3, 0
s_cbranch_scc1 L_XCC_1
s_getreg_b32 s70, hwreg(HW_REG_XCC_ID, 0, 4)
s_lshl_b32 s71, s2, 3
s_add_u32 s71, s71, 57344
v_mov_b32 v14, s70
v_mov_b32 v15, s11
s_mov_b64 exec, 1
buffer_store_dwordx2 v[14:15], off, s[12:15], s71 sc1
s_mov_b64 exec, -1
L_XCC_1:
v_and_b32 v12, 3, v0
v_bfe_u32 v13, v0, 2, 1
v_lshl_add_u32 v12, v13, 4, v12
v_bfe_u32 v13, v0, 3, 2
v_lshl_add_u32 v12, v13, 2, v12
v_bfe_u32 v13, v12, 1, 3
s_lshl_b32 s73, s7, 5
v_add_u32 v12, s73, v12
v_lshlrev_b32 v12, 7, v12
v_lshrrev_b32 v14, 5, v0
v_xor_b32 v13, v13, v14
v_lshl_add_u32 v12, v13, 4, v12
v_add_u32 v4, 81920, v12
v_xor_b32 v5, 32, v4
v_xor_b32 v6, 64, v4
v_xor_b32 v7, 96, v4
v_bfe_u32 v12, v0, 1, 3
v_and_b32 v13, 1, v0
v_lshl_add_u32 v12, v13, 3, v12
v_bfe_u32 v13, v0, 4, 1
v_lshl_add_u32 v12, v13, 4, v12
v_bfe_u32 v13, v12, 1, 3
v_lshrrev_b32 v14, 5, v0
v_xor_b32 v13, v13, v14
v_lshlrev_b32 v12, 7, v12
v_lshl_add_u32 v12, v13, 4, v12
s_mul_i32 s73, s8, 12288
s_add_u32 s73, s73, 98304
v_add_u32 v8, s73, v12
v_xor_b32 v9, 32, v8
v_xor_b32 v10, 64, v8
v_xor_b32 v11, 96, v8
v_mov_b32 v48, 0
v_mov_b32 v49, 0
v_mov_b32 v50, 0
v_mov_b32 v51, 0
v_mov_b32 v52, 0
v_mov_b32 v53, 0
v_mov_b32 v54, 0
v_mov_b32 v55, 0
v_mov_b32 v56, 0
v_mov_b32 v57, 0
v_mov_b32 v58, 0
v_mov_b32 v59, 0
v_mov_b32 v60, 0
v_mov_b32 v61, 0
v_mov_b32 v62, 0
v_mov_b32 v63, 0
v_mov_b32 v64, 0
v_mov_b32 v65, 0
v_mov_b32 v66, 0
v_mov_b32 v67, 0
v_mov_b32 v68, 0
v_mov_b32 v69, 0
v_mov_b32 v70, 0
v_mov_b32 v71, 0
v_mov_b32 v72, 0
v_mov_b32 v73, 0
v_mov_b32 v74, 0
v_mov_b32 v75, 0
v_mov_b32 v76, 0
v_mov_b32 v77, 0
v_mov_b32 v78, 0
v_mov_b32 v79, 0
v_mov_b32 v80, 0
v_mov_b32 v81, 0
v_mov_b32 v82, 0
v_mov_b32 v83, 0
v_mov_b32 v84, 0
v_mov_b32 v85, 0
v_mov_b32 v86, 0
v_mov_b32 v87, 0
v_mov_b32 v88, 0
v_mov_b32 v89, 0
v_mov_b32 v90, 0
v_mov_b32 v91, 0
v_mov_b32 v92, 0
v_mov_b32 v93, 0
v_mov_b32 v94, 0
v_mov_b32 v95, 0
s_cmp_eq_u32 s8, 1
s_cbranch_scc1 L_CS1
s_waitcnt lgkmcnt(0)
s_barrier
ds_read_b128 v[16:19], v4
ds_read_b128 v[20:23], v8 offset:0
ds_read_b128 v[24:27], v8 offset:4096
ds_read_b128 v[28:31], v8 offset:8192
s_mov_b32 s70, 0
s_mov_b32 s71, 2
L_P1_S0:
s_waitcnt lgkmcnt(0)
v_mfma_f32_32x32x16_bf16 v[48:63], v[16:19], v[20:23], v[48:63]
ds_read_b128 v[32:35], v5
ds_read_b128 v[36:39], v9 offset:0
v_mfma_f32_32x32x16_bf16 v[64:79], v[16:19], v[24:27], v[64:79]
ds_read_b128 v[40:43], v9 offset:4096
ds_read_b128 v[44:47], v9 offset:8192
v_mfma_f32_32x32x16_bf16 v[80:95], v[16:19], v[28:31], v[80:95]
s_waitcnt lgkmcnt(0)
v_mfma_f32_32x32x16_bf16 v[48:63], v[32:35], v[36:39], v[48:63]
ds_read_b128 v[16:19], v6
ds_read_b128 v[20:23], v10 offset:0
v_mfma_f32_32x32x16_bf16 v[64:79], v[32:35], v[40:43], v[64:79]
ds_read_b128 v[24:27], v10 offset:4096
ds_read_b128 v[28:31], v10 offset:8192
v_mfma_f32_32x32x16_bf16 v[80:95], v[32:35], v[44:47], v[80:95]
s_waitcnt lgkmcnt(0)
v_mfma_f32_32x32x16_bf16 v[48:63], v[16:19], v[20:23], v[48:63]
ds_read_b128 v[32:35], v7
ds_read_b128 v[36:39], v11 offset:0
v_mfma_f32_32x32x16_bf16 v[64:79], v[16:19], v[24:27], v[64:79]
ds_read_b128 v[40:43], v11 offset:4096
ds_read_b128 v[44:47], v11 offset:8192
v_mfma_f32_32x32x16_bf16 v[80:95], v[16:19], v[28:31], v[80:95]
s_mov_b32 s72, 40960
s_cmp_eq_u32 s71, 2
s_cselect_b32 s72, 4294885376, s72
s_cselect_b32 s71, -1, s71
s_add_u32 s71, s71, 1
v_add_u32 v4, s72, v4
v_add_u32 v5, s72, v5
v_add_u32 v6, s72, v6
v_add_u32 v7, s72, v7
v_add_u32 v8, s72, v8
v_add_u32 v9, s72, v9
v_add_u32 v10, s72, v10
v_add_u32 v11, s72, v11
s_waitcnt lgkmcnt(0)
v_mfma_f32_32x32x16_bf16 v[48:63], v[32:35], v[36:39], v[48:63]
s_cmp_eq_u32 s70, 9
s_cbranch_scc1 L_P1_S0_last
s_cmp_lg_u32 s70, 3
s_cbranch_scc1 L_P1_S0_nw
s_waitcnt vmcnt(0)
L_P1_S0_nw:
s_barrier
s_cmp_lg_u32 s70, 3
s_cbranch_scc1 L_P1_S0_nf
s_cmp_lg_u32 s3, 0
s_cbranch_scc1 L_P1_S0_nf
v_mov_b32 v2, s11
s_lshl_b32 s73, s2, 2
s_add_u32 s73, s73, 4096
s_mov_b64 exec, 1
buffer_store_dword v2, off, s[12:15], s73 sc1
s_mov_b64 exec, -1
L_P1_S0_nf:
ds_read_b128 v[16:19], v4
ds_read_b128 v[20:23], v8 offset:0
v_mfma_f32_32x32x16_bf16 v[64:79], v[32:35], v[40:43], v[64:79]
ds_read_b128 v[24:27], v8 offset:4096
ds_read_b128 v[28:31], v8 offset:8192
v_mfma_f32_32x32x16_bf16 v[80:95], v[32:35], v[44:47], v[80:95]
s_add_u32 s70, s70, 1
s_branch L_P1_S0
L_P1_S0_last:
v_mfma_f32_32x32x16_bf16 v[64:79], v[32:35], v[40:43], v[64:79]
v_mfma_f32_32x32x16_bf16 v[80:95], v[32:35], v[44:47], v[80:95]
s_barrier
v_mov_b32 v12, 163712
ds_read_b32 v2, v12
v_and_b32 v12, 3, v0
v_bfe_u32 v13, v0, 2, 1
v_lshl_add_u32 v12, v13, 4, v12
v_bfe_u32 v13, v0, 3, 2
v_lshl_add_u32 v12, v13, 2, v12
s_lshl_b32 s73, s7, 5
v_add_u32 v13, s73, v12
v_lshlrev_b32 v13, 4, v13
v_add_u32 v13, 153600, v13
v_mov_b32 v14, 155648
v_cmp_gt_u32 vcc, 32, v0
s_nop 1
v_cndmask_b32 v13, v14, v13, vcc
ds_read_b128 v[16:19], v13
v_and_b32 v12, 31, v0
s_mul_i32 s73, s8, 96
v_add_u32 v11, s73, v12
v_lshlrev_b32 v12, 4, v11
v_add_u32 v12, 155904, v12
ds_read_b128 v[20:23], v12 offset:0
ds_read_b128 v[24:27], v12 offset:512
ds_read_b128 v[28:31], v12 offset:1024
v_lshlrev_b32 v14, 4, v11
v_add_u32 v14, 160000, v14
ds_read_b128 v[96:99], v14 offset:0
ds_read_b128 v[100:103], v14 offset:512
ds_read_b128 v[104:107], v14 offset:1024
v_lshrrev_b32 v13, 5, v0
v_lshlrev_b32 v13, 6, v13
s_lshl_b32 s73, s7, 7
s_add_u32 s73, s73, 163200
v_add_u32 v13, s73, v13
ds_read_b128 v[32:35], v13 offset:0
ds_read_b128 v[36:39], v13 offset:16
ds_read_b128 v[40:43], v13 offset:32
ds_read_b128 v[44:47], v13 offset:48
s_waitcnt lgkmcnt(4)
v_readfirstlane_b32 s96, v2
v_mfma_f32_32x32x16_bf16 v[48:63], v[16:19], v[20:23], v[48:63]
v_mfma_f32_32x32x16_bf16 v[64:79], v[16:19], v[24:27], v[64:79]
v_mfma_f32_32x32x16_bf16 v[80:95], v[16:19], v[28:31], v[80:95]
s_waitcnt lgkmcnt(0)
s_nop 8
v_pk_mul_f32 v[48:49], v[48:49], v[32:33]
v_pk_mul_f32 v[50:51], v[50:51], v[34:35]
v_pk_mul_f32 v[52:53], v[52:53], v[36:37]
v_pk_mul_f32 v[54:55], v[54:55], v[38:39]
v_pk_mul_f32 v[56:57], v[56:57], v[40:41]
v_pk_mul_f32 v[58:59], v[58:59], v[42:43]
v_pk_mul_f32 v[60:61], v[60:61], v[44:45]
v_pk_mul_f32 v[62:63], v[62:63], v[46:47]
v_pk_mul_f32 v[64:65], v[64:65], v[32:33]
v_pk_mul_f32 v[66:67], v[66:67], v[34:35]
v_pk_mul_f32 v[68:69], v[68:69], v[36:37]
v_pk_mul_f32 v[70:71], v[70:71], v[38:39]
v_pk_mul_f32 v[72:73], v[72:73], v[40:41]
v_pk_mul_f32 v[74:75], v[74:75], v[42:43]
v_pk_mul_f32 v[76:77], v[76:77], v[44:45]
v_pk_mul_f32 v[78:79], v[78:79], v[46:47]
v_pk_mul_f32 v[80:81], v[80:81], v[32:33]
v_pk_mul_f32 v[82:83], v[82:83], v[34:35]
v_pk_mul_f32 v[84:85], v[84:85], v[36:37]
v_pk_mul_f32 v[86:87], v[86:87], v[38:39]
v_pk_mul_f32 v[88:89], v[88:89], v[40:41]
v_pk_mul_f32 v[90:91], v[90:91], v[42:43]
v_pk_mul_f32 v[92:93], v[92:93], v[44:45]
v_pk_mul_f32 v[94:95], v[94:95], v[46:47]
v_mul_f32_dpp v16, v48, v99 quad_perm:[1,0,3,2] row_mask:0xf bank_mask:0xf
v_mul_f32_dpp v17, v64, v103 quad_perm:[1,0,3,2] row_mask:0xf bank_mask:0xf
v_mul_f32_dpp v18, v80, v107 quad_perm:[1,0,3,2] row_mask:0xf bank_mask:0xf
v_fma_f32 v48, v48, v98, v16
v_fma_f32 v64, v64, v102, v17
v_fma_f32 v80, v80, v106, v18
v_mul_f32_dpp v16, v49, v99 quad_perm:[1,0,3,2] row_mask:0xf bank_mask:0xf
v_mul_f32_dpp v17, v65, v103 quad_perm:[1,0,3,2] row_mask:0xf bank_mask:0xf
v_mul_f32_dpp v18, v81, v107 quad_perm:[1,0,3,2] row_mask:0xf bank_mask:0xf
v_fma_f32 v49, v49, v98, v16
v_fma_f32 v65, v65, v102, v17
v_fma_f32 v81, v81, v106, v18
v_mul_f32_dpp v16, v50, v99 quad_perm:[1,0,3,2] row_mask:0xf bank_mask:0xf
v_mul_f32_dpp v17, v66, v103 quad_perm:[1,0,3,2] row_mask:0xf bank_mask:0xf
v_mul_f32_dpp v18, v82, v107 quad_perm:[1,0,3,2] row_mask:0xf bank_mask:0xf
v_fma_f32 v50, v50, v98, v16
v_fma_f32 v66, v66, v102, v17
v_fma_f32 v82, v82, v106, v18
v_mul_f32_dpp v16, v51, v99 quad_perm:[1,0,3,2] row_mask:0xf bank_mask:0xf
v_mul_f32_dpp v17, v67, v103 quad_perm:[1,0,3,2] row_mask:0xf bank_mask:0xf
v_mul_f32_dpp v18, v83, v107 quad_perm:[1,0,3,2] row_mask:0xf bank_mask:0xf
v_fma_f32 v51, v51, v98, v16
v_fma_f32 v67, v67, v102, v17
v_fma_f32 v83, v83, v106, v18
v_mul_f32_dpp v16, v52, v99 quad_perm:[1,0,3,2] row_mask:0xf bank_mask:0xf
v_mul_f32_dpp v17, v68, v103 quad_perm:[1,0,3,2] row_mask:0xf bank_mask:0xf
v_mul_f32_dpp v18, v84, v107 quad_perm:[1,0,3,2] row_mask:0xf bank_mask:0xf
v_fma_f32 v52, v52, v98, v16
v_fma_f32 v68, v68, v102, v17
v_fma_f32 v84, v84, v106, v18
v_mul_f32_dpp v16, v53, v99 quad_perm:[1,0,3,2] row_mask:0xf bank_mask:0xf
v_mul_f32_dpp v17, v69, v103 quad_perm:[1,0,3,2] row_mask:0xf bank_mask:0xf
v_mul_f32_dpp v18, v85, v107 quad_perm:[1,0,3,2] row_mask:0xf bank_mask:0xf
v_fma_f32 v53, v53, v98, v16
v_fma_f32 v69, v69, v102, v17
v_fma_f32 v85, v85, v106, v18
v_mul_f32_dpp v16, v54, v99 quad_perm:[1,0,3,2] row_mask:0xf bank_mask:0xf
v_mul_f32_dpp v17, v70, v103 quad_perm:[1,0,3,2] row_mask:0xf bank_mask:0xf
v_mul_f32_dpp v18, v86, v107 quad_perm:[1,0,3,2] row_mask:0xf bank_mask:0xf
v_fma_f32 v54, v54, v98, v16
v_fma_f32 v70, v70, v102, v17
v_fma_f32 v86, v86, v106, v18
v_mul_f32_dpp v16, v55, v99 quad_perm:[1,0,3,2] row_mask:0xf bank_mask:0xf
v_mul_f32_dpp v17, v71, v103 quad_perm:[1,0,3,2] row_mask:0xf bank_mask:0xf
v_mul_f32_dpp v18, v87, v107 quad_perm:[1,0,3,2] row_mask:0xf bank_mask:0xf
v_fma_f32 v55, v55, v98, v16
v_fma_f32 v71, v71, v102, v17
v_fma_f32 v87, v87, v106, v18
v_mul_f32_dpp v16, v56, v99 quad_perm:[1,0,3,2] row_mask:0xf bank_mask:0xf
v_mul_f32_dpp v17, v72, v103 quad_perm:[1,0,3,2] row_mask:0xf bank_mask:0xf
v_mul_f32_dpp v18, v88, v107 quad_perm:[1,0,3,2] row_mask:0xf bank_mask:0xf
v_fma_f32 v56, v56, v98, v16
v_fma_f32 v72, v72, v102, v17
v_fma_f32 v88, v88, v106, v18
v_mul_f32_dpp v16, v57, v99 quad_perm:[1,0,3,2] row_mask:0xf bank_mask:0xf
v_mul_f32_dpp v17, v73, v103 quad_perm:[1,0,3,2] row_mask:0xf bank_mask:0xf
v_mul_f32_dpp v18, v89, v107 quad_perm:[1,0,3,2] row_mask:0xf bank_mask:0xf
v_fma_f32 v57, v57, v98, v16
v_fma_f32 v73, v73, v102, v17
v_fma_f32 v89, v89, v106, v18
v_mul_f32_dpp v16, v58, v99 quad_perm:[1,0,3,2] row_mask:0xf bank_mask:0xf
v_mul_f32_dpp v17, v74, v103 quad_perm:[1,0,3,2] row_mask:0xf bank_mask:0xf
v_mul_f32_dpp v18, v90, v107 quad_perm:[1,0,3,2] row_mask:0xf bank_mask:0xf
v_fma_f32 v58, v58, v98, v16
v_fma_f32 v74, v74, v102, v17
v_fma_f32 v90, v90, v106, v18
v_mul_f32_dpp v16, v59, v99 quad_perm:[1,0,3,2] row_mask:0xf bank_mask:0xf
v_mul_f32_dpp v17, v75, v103 quad_perm:[1,0,3,2] row_mask:0xf bank_mask:0xf
v_mul_f32_dpp v18, v91, v107 quad_perm:[1,0,3,2] row_mask:0xf bank_mask:0xf
v_fma_f32 v59, v59, v98, v16
v_fma_f32 v75, v75, v102, v17
v_fma_f32 v91, v91, v106, v18
v_mul_f32_dpp v16, v60, v99 quad_perm:[1,0,3,2] row_mask:0xf bank_mask:0xf
v_mul_f32_dpp v17, v76, v103 quad_perm:[1,0,3,2] row_mask:0xf bank_mask:0xf
v_mul_f32_dpp v18, v92, v107 quad_perm:[1,0,3,2] row_mask:0xf bank_mask:0xf
v_fma_f32 v60, v60, v98, v16
v_fma_f32 v76, v76, v102, v17
v_fma_f32 v92, v92, v106, v18
v_mul_f32_dpp v16, v61, v99 quad_perm:[1,0,3,2] row_mask:0xf bank_mask:0xf
v_mul_f32_dpp v17, v77, v103 quad_perm:[1,0,3,2] row_mask:0xf bank_mask:0xf
v_mul_f32_dpp v18, v93, v107 quad_perm:[1,0,3,2] row_mask:0xf bank_mask:0xf
v_fma_f32 v61, v61, v98, v16
v_fma_f32 v77, v77, v102, v17
v_fma_f32 v93, v93, v106, v18
v_mul_f32_dpp v16, v62, v99 quad_perm:[1,0,3,2] row_mask:0xf bank_mask:0xf
v_mul_f32_dpp v17, v78, v103 quad_perm:[1,0,3,2] row_mask:0xf bank_mask:0xf
v_mul_f32_dpp v18, v94, v107 quad_perm:[1,0,3,2] row_mask:0xf bank_mask:0xf
v_fma_f32 v62, v62, v98, v16
v_fma_f32 v78, v78, v102, v17
v_fma_f32 v94, v94, v106, v18
v_mul_f32_dpp v16, v63, v99 quad_perm:[1,0,3,2] row_mask:0xf bank_mask:0xf
v_mul_f32_dpp v17, v79, v103 quad_perm:[1,0,3,2] row_mask:0xf bank_mask:0xf
v_mul_f32_dpp v18, v95, v107 quad_perm:[1,0,3,2] row_mask:0xf bank_mask:0xf
v_fma_f32 v63, v63, v98, v16
v_fma_f32 v79, v79, v102, v17
v_fma_f32 v95, v95, v106, v18
v_fma_f32 v20, v48, v96, v49
v_fma_f32 v21, v64, v100, v65
v_fma_f32 v22, v80, v104, v81
v_fmac_f32_dpp v20, v48, v97 quad_perm:[1,0,3,2] row_mask:0xf bank_mask:0xf
v_fmac_f32_dpp v21, v64, v101 quad_perm:[1,0,3,2] row_mask:0xf bank_mask:0xf
v_fmac_f32_dpp v22, v80, v105 quad_perm:[1,0,3,2] row_mask:0xf bank_mask:0xf
v_fma_f32 v24, v20, v96, v50
v_fma_f32 v25, v21, v100, v66
v_fma_f32 v26, v22, v104, v82
v_fmac_f32_dpp v24, v20, v97 quad_perm:[1,0,3,2] row_mask:0xf bank_mask:0xf
v_fmac_f32_dpp v25, v21, v101 quad_perm:[1,0,3,2] row_mask:0xf bank_mask:0xf
v_fmac_f32_dpp v26, v22, v105 quad_perm:[1,0,3,2] row_mask:0xf bank_mask:0xf
v_fma_f32 v20, v24, v96, v51
v_fma_f32 v21, v25, v100, v67
v_fma_f32 v22, v26, v104, v83
v_fmac_f32_dpp v20, v24, v97 quad_perm:[1,0,3,2] row_mask:0xf bank_mask:0xf
v_fmac_f32_dpp v21, v25, v101 quad_perm:[1,0,3,2] row_mask:0xf bank_mask:0xf
v_fmac_f32_dpp v22, v26, v105 quad_perm:[1,0,3,2] row_mask:0xf bank_mask:0xf
v_fma_f32 v24, v20, v96, v52
v_fma_f32 v25, v21, v100, v68
v_fma_f32 v26, v22, v104, v84
v_fmac_f32_dpp v24, v20, v97 quad_perm:[1,0,3,2] row_mask:0xf bank_mask:0xf
v_fmac_f32_dpp v25, v21, v101 quad_perm:[1,0,3,2] row_mask:0xf bank_mask:0xf
v_fmac_f32_dpp v26, v22, v105 quad_perm:[1,0,3,2] row_mask:0xf bank_mask:0xf
v_fma_f32 v20, v24, v96, v53
v_fma_f32 v21, v25, v100, v69
v_fma_f32 v22, v26, v104, v85
v_fmac_f32_dpp v20, v24, v97 quad_perm:[1,0,3,2] row_mask:0xf bank_mask:0xf
v_fmac_f32_dpp v21, v25, v101 quad_perm:[1,0,3,2] row_mask:0xf bank_mask:0xf
v_fmac_f32_dpp v22, v26, v105 quad_perm:[1,0,3,2] row_mask:0xf bank_mask:0xf
v_fma_f32 v24, v20, v96, v54
v_fma_f32 v25, v21, v100, v70
v_fma_f32 v26, v22, v104, v86
v_fmac_f32_dpp v24, v20, v97 quad_perm:[1,0,3,2] row_mask:0xf bank_mask:0xf
v_fmac_f32_dpp v25, v21, v101 quad_perm:[1,0,3,2] row_mask:0xf bank_mask:0xf
v_fmac_f32_dpp v26, v22, v105 quad_perm:[1,0,3,2] row_mask:0xf bank_mask:0xf
v_fma_f32 v20, v24, v96, v55
v_fma_f32 v21, v25, v100, v71
v_fma_f32 v22, v26, v104, v87
v_fmac_f32_dpp v20, v24, v97 quad_perm:[1,0,3,2] row_mask:0xf bank_mask:0xf
v_fmac_f32_dpp v21, v25, v101 quad_perm:[1,0,3,2] row_mask:0xf bank_mask:0xf
v_fmac_f32_dpp v22, v26, v105 quad_perm:[1,0,3,2] row_mask:0xf bank_mask:0xf
v_fma_f32 v24, v20, v96, v56
v_fma_f32 v25, v21, v100, v72
v_fma_f32 v26, v22, v104, v88
v_fmac_f32_dpp v24, v20, v97 quad_perm:[1,0,3,2] row_mask:0xf bank_mask:0xf
v_fmac_f32_dpp v25, v21, v101 quad_perm:[1,0,3,2] row_mask:0xf bank_mask:0xf
v_fmac_f32_dpp v26, v22, v105 quad_perm:[1,0,3,2] row_mask:0xf bank_mask:0xf
v_fma_f32 v20, v24, v96, v57
v_fma_f32 v21, v25, v100, v73
v_fma_f32 v22, v26, v104, v89
v_fmac_f32_dpp v20, v24, v97 quad_perm:[1,0,3,2] row_mask:0xf bank_mask:0xf
v_fmac_f32_dpp v21, v25, v101 quad_perm:[1,0,3,2] row_mask:0xf bank_mask:0xf
v_fmac_f32_dpp v22, v26, v105 quad_perm:[1,0,3,2] row_mask:0xf bank_mask:0xf
v_fma_f32 v24, v20, v96, v58
v_fma_f32 v25, v21, v100, v74
v_fma_f32 v26, v22, v104, v90
v_fmac_f32_dpp v24, v20, v97 quad_perm:[1,0,3,2] row_mask:0xf bank_mask:0xf
v_fmac_f32_dpp v25, v21, v101 quad_perm:[1,0,3,2] row_mask:0xf bank_mask:0xf
v_fmac_f32_dpp v26, v22, v105 quad_perm:[1,0,3,2] row_mask:0xf bank_mask:0xf
v_fma_f32 v20, v24, v96, v59
v_fma_f32 v21, v25, v100, v75
v_fma_f32 v22, v26, v104, v91
v_fmac_f32_dpp v20, v24, v97 quad_perm:[1,0,3,2] row_mask:0xf bank_mask:0xf
v_fmac_f32_dpp v21, v25, v101 quad_perm:[1,0,3,2] row_mask:0xf bank_mask:0xf
v_fmac_f32_dpp v22, v26, v105 quad_perm:[1,0,3,2] row_mask:0xf bank_mask:0xf
v_fma_f32 v24, v20, v96, v60
v_fma_f32 v25, v21, v100, v76
v_fma_f32 v26, v22, v104, v92
v_fmac_f32_dpp v24, v20, v97 quad_perm:[1,0,3,2] row_mask:0xf bank_mask:0xf
v_fmac_f32_dpp v25, v21, v101 quad_perm:[1,0,3,2] row_mask:0xf bank_mask:0xf
v_fmac_f32_dpp v26, v22, v105 quad_perm:[1,0,3,2] row_mask:0xf bank_mask:0xf
v_fma_f32 v20, v24, v96, v61
v_fma_f32 v21, v25, v100, v77
v_fma_f32 v22, v26, v104, v93
v_fmac_f32_dpp v20, v24, v97 quad_perm:[1,0,3,2] row_mask:0xf bank_mask:0xf
v_fmac_f32_dpp v21, v25, v101 quad_perm:[1,0,3,2] row_mask:0xf bank_mask:0xf
v_fmac_f32_dpp v22, v26, v105 quad_perm:[1,0,3,2] row_mask:0xf bank_mask:0xf
v_fma_f32 v24, v20, v96, v62
v_fma_f32 v25, v21, v100, v78
v_fma_f32 v26, v22, v104, v94
v_fmac_f32_dpp v24, v20, v97 quad_perm:[1,0,3,2] row_mask:0xf bank_mask:0xf
v_fmac_f32_dpp v25, v21, v101 quad_perm:[1,0,3,2] row_mask:0xf bank_mask:0xf
v_fmac_f32_dpp v26, v22, v105 quad_perm:[1,0,3,2] row_mask:0xf bank_mask:0xf
v_fma_f32 v20, v24, v96, v63
v_fma_f32 v21, v25, v100, v79
v_fma_f32 v22, v26, v104, v95
v_fmac_f32_dpp v20, v24, v97 quad_perm:[1,0,3,2] row_mask:0xf bank_mask:0xf
v_fmac_f32_dpp v21, v25, v101 quad_perm:[1,0,3,2] row_mask:0xf bank_mask:0xf
v_fmac_f32_dpp v22, v26, v105 quad_perm:[1,0,3,2] row_mask:0xf bank_mask:0xf
v_lshrrev_b32 v13, 5, v0
v_mul_u32_u24 v13, 640, v13
v_lshl_add_u32 v13, v11, 2, v13
s_mul_i32 s73, s7, 1280
s_add_u32 s73, s73, 148480
v_add_u32 v13, s73, v13
ds_write_b32 v13, v20 offset:0
ds_write_b32 v13, v21 offset:128
ds_write_b32 v13, v22 offset:256
s_waitcnt lgkmcnt(0)
s_barrier
s_lshl_b32 s73, s3, 11
s_add_u32 s73, s73, 81920
v_and_b32 v12, 31, v0
v_bfe_u32 v14, v0, 2, 2
v_lshrrev_b32 v15, 5, v0
v_lshlrev_b32 v15, 1, v15
v_xor_b32 v14, v14, v15
v_lshlrev_b32 v12, 6, v12
v_lshl_add_u32 v8, v14, 4, v12
v_add_u32 v8, s73, v8
v_xor_b32 v9, 16, v8
v_bfe_u32 v12, v0, 2, 2
v_lshrrev_b32 v13, 5, v0
v_lshl_add_u32 v12, v13, 3, v12
v_lshlrev_b32 v12, 6, v12
v_bfe_u32 v14, v0, 4, 1
v_bfe_u32 v15, v0, 1, 1
v_lshl_add_u32 v14, v14, 1, v15
v_lshlrev_b32 v13, 1, v13
v_xor_b32 v14, v14, v13
v_and_b32 v15, 1, v0
v_lshl_add_u32 v12, v15, 3, v12
v_add_u32 v12, s73, v12
v_lshl_add_u32 v10, v14, 4, v12
v_xor_b32 v14, 1, v14
v_lshl_add_u32 v7, v14, 4, v12
v_add_u32 v7, 256, v7
v_lshrrev_b32 v13, 5, v0
v_mul_u32_u24 v13, 640, v13
v_lshl_add_u32 v13, v11, 2, v13
s_mul_i32 s73, s7, 1280
s_add_u32 s73, s73, 148480
v_add_u32 v13, s73, v13
s_barrier
ds_read_b32 v16, v13 offset:0
ds_read_b32 v17, v13 offset:128
ds_read_b32 v18, v13 offset:256
s_waitcnt lgkmcnt(0)
v_fmac_f32 v48, v16, v96
v_fmac_f32 v64, v17, v100
v_fmac_f32 v80, v18, v104
v_fmac_f32_dpp v48, v16, v97 quad_perm:[1,0,3,2] row_mask:0xf bank_mask:0xf
v_fmac_f32_dpp v64, v17, v101 quad_perm:[1,0,3,2] row_mask:0xf bank_mask:0xf
v_fmac_f32_dpp v80, v18, v105 quad_perm:[1,0,3,2] row_mask:0xf bank_mask:0xf
v_fmac_f32 v49, v48, v96
v_fmac_f32 v65, v64, v100
v_fmac_f32 v81, v80, v104
v_fmac_f32_dpp v49, v48, v97 quad_perm:[1,0,3,2] row_mask:0xf bank_mask:0xf
v_fmac_f32_dpp v65, v64, v101 quad_perm:[1,0,3,2] row_mask:0xf bank_mask:0xf
v_fmac_f32_dpp v81, v80, v105 quad_perm:[1,0,3,2] row_mask:0xf bank_mask:0xf
v_fmac_f32 v50, v49, v96
v_fmac_f32 v66, v65, v100
v_fmac_f32 v82, v81, v104
v_fmac_f32_dpp v50, v49, v97 quad_perm:[1,0,3,2] row_mask:0xf bank_mask:0xf
v_fmac_f32_dpp v66, v65, v101 quad_perm:[1,0,3,2] row_mask:0xf bank_mask:0xf
v_fmac_f32_dpp v82, v81, v105 quad_perm:[1,0,3,2] row_mask:0xf bank_mask:0xf
v_fmac_f32 v51, v50, v96
v_fmac_f32 v67, v66, v100
v_fmac_f32 v83, v82, v104
v_fmac_f32_dpp v51, v50, v97 quad_perm:[1,0,3,2] row_mask:0xf bank_mask:0xf
v_fmac_f32_dpp v67, v66, v101 quad_perm:[1,0,3,2] row_mask:0xf bank_mask:0xf
v_fmac_f32_dpp v83, v82, v105 quad_perm:[1,0,3,2] row_mask:0xf bank_mask:0xf
v_fmac_f32 v52, v51, v96
v_fmac_f32 v68, v67, v100
v_fmac_f32 v84, v83, v104
v_fmac_f32_dpp v52, v51, v97 quad_perm:[1,0,3,2] row_mask:0xf bank_mask:0xf
v_fmac_f32_dpp v68, v67, v101 quad_perm:[1,0,3,2] row_mask:0xf bank_mask:0xf
v_fmac_f32_dpp v84, v83, v105 quad_perm:[1,0,3,2] row_mask:0xf bank_mask:0xf
v_fmac_f32 v53, v52, v96
v_fmac_f32 v69, v68, v100
v_fmac_f32 v85, v84, v104
v_fmac_f32_dpp v53, v52, v97 quad_perm:[1,0,3,2] row_mask:0xf bank_mask:0xf
v_fmac_f32_dpp v69, v68, v101 quad_perm:[1,0,3,2] row_mask:0xf bank_mask:0xf
v_fmac_f32_dpp v85, v84, v105 quad_perm:[1,0,3,2] row_mask:0xf bank_mask:0xf
v_fmac_f32 v54, v53, v96
v_fmac_f32 v70, v69, v100
v_fmac_f32 v86, v85, v104
v_fmac_f32_dpp v54, v53, v97 quad_perm:[1,0,3,2] row_mask:0xf bank_mask:0xf
v_fmac_f32_dpp v70, v69, v101 quad_perm:[1,0,3,2] row_mask:0xf bank_mask:0xf
v_fmac_f32_dpp v86, v85, v105 quad_perm:[1,0,3,2] row_mask:0xf bank_mask:0xf
v_fmac_f32 v55, v54, v96
v_fmac_f32 v71, v70, v100
v_fmac_f32 v87, v86, v104
v_fmac_f32_dpp v55, v54, v97 quad_perm:[1,0,3,2] row_mask:0xf bank_mask:0xf
v_fmac_f32_dpp v71, v70, v101 quad_perm:[1,0,3,2] row_mask:0xf bank_mask:0xf
v_fmac_f32_dpp v87, v86, v105 quad_perm:[1,0,3,2] row_mask:0xf bank_mask:0xf
v_fmac_f32 v56, v55, v96
v_fmac_f32 v72, v71, v100
v_fmac_f32 v88, v87, v104
v_fmac_f32_dpp v56, v55, v97 quad_perm:[1,0,3,2] row_mask:0xf bank_mask:0xf
v_fmac_f32_dpp v72, v71, v101 quad_perm:[1,0,3,2] row_mask:0xf bank_mask:0xf
v_fmac_f32_dpp v88, v87, v105 quad_perm:[1,0,3,2] row_mask:0xf bank_mask:0xf
v_fmac_f32 v57, v56, v96
v_fmac_f32 v73, v72, v100
v_fmac_f32 v89, v88, v104
v_fmac_f32_dpp v57, v56, v97 quad_perm:[1,0,3,2] row_mask:0xf bank_mask:0xf
v_fmac_f32_dpp v73, v72, v101 quad_perm:[1,0,3,2] row_mask:0xf bank_mask:0xf
v_fmac_f32_dpp v89, v88, v105 quad_perm:[1,0,3,2] row_mask:0xf bank_mask:0xf
v_fmac_f32 v58, v57, v96
v_fmac_f32 v74, v73, v100
v_fmac_f32 v90, v89, v104
v_fmac_f32_dpp v58, v57, v97 quad_perm:[1,0,3,2] row_mask:0xf bank_mask:0xf
v_fmac_f32_dpp v74, v73, v101 quad_perm:[1,0,3,2] row_mask:0xf bank_mask:0xf
v_fmac_f32_dpp v90, v89, v105 quad_perm:[1,0,3,2] row_mask:0xf bank_mask:0xf
v_fmac_f32 v59, v58, v96
v_fmac_f32 v75, v74, v100
v_fmac_f32 v91, v90, v104
v_fmac_f32_dpp v59, v58, v97 quad_perm:[1,0,3,2] row_mask:0xf bank_mask:0xf
v_fmac_f32_dpp v75, v74, v101 quad_perm:[1,0,3,2] row_mask:0xf bank_mask:0xf
v_fmac_f32_dpp v91, v90, v105 quad_perm:[1,0,3,2] row_mask:0xf bank_mask:0xf
v_fmac_f32 v60, v59, v96
v_fmac_f32 v76, v75, v100
v_fmac_f32 v92, v91, v104
v_fmac_f32_dpp v60, v59, v97 quad_perm:[1,0,3,2] row_mask:0xf bank_mask:0xf
v_fmac_f32_dpp v76, v75, v101 quad_perm:[1,0,3,2] row_mask:0xf bank_mask:0xf
v_fmac_f32_dpp v92, v91, v105 quad_perm:[1,0,3,2] row_mask:0xf bank_mask:0xf
v_fmac_f32 v61, v60, v96
v_fmac_f32 v77, v76, v100
v_fmac_f32 v93, v92, v104
v_fmac_f32_dpp v61, v60, v97 quad_perm:[1,0,3,2] row_mask:0xf bank_mask:0xf
v_fmac_f32_dpp v77, v76, v101 quad_perm:[1,0,3,2] row_mask:0xf bank_mask:0xf
v_fmac_f32_dpp v93, v92, v105 quad_perm:[1,0,3,2] row_mask:0xf bank_mask:0xf
v_fmac_f32 v62, v61, v96
v_fmac_f32 v78, v77, v100
v_fmac_f32 v94, v93, v104
v_fmac_f32_dpp v62, v61, v97 quad_perm:[1,0,3,2] row_mask:0xf bank_mask:0xf
v_fmac_f32_dpp v78, v77, v101 quad_perm:[1,0,3,2] row_mask:0xf bank_mask:0xf
v_fmac_f32_dpp v94, v93, v105 quad_perm:[1,0,3,2] row_mask:0xf bank_mask:0xf
v_fmac_f32 v63, v62, v96
v_fmac_f32 v79, v78, v100
v_fmac_f32 v95, v94, v104
v_fmac_f32_dpp v63, v62, v97 quad_perm:[1,0,3,2] row_mask:0xf bank_mask:0xf
v_fmac_f32_dpp v79, v78, v101 quad_perm:[1,0,3,2] row_mask:0xf bank_mask:0xf
v_fmac_f32_dpp v95, v94, v105 quad_perm:[1,0,3,2] row_mask:0xf bank_mask:0xf
v_cvt_pk_bf16_f32 v40, v48, v49
v_cvt_pk_bf16_f32 v41, v50, v51
v_cvt_pk_bf16_f32 v42, v52, v53
v_cvt_pk_bf16_f32 v43, v54, v55
v_cvt_pk_bf16_f32 v44, v56, v57
v_cvt_pk_bf16_f32 v45, v58, v59
v_cvt_pk_bf16_f32 v46, v60, v61
v_cvt_pk_bf16_f32 v47, v62, v63
ds_write_b128 v8, v[40:43]
ds_write_b128 v9, v[44:47]
ds_read_b64_tr_b16 v[16:17], v10 offset:0
ds_read_b64_tr_b16 v[18:19], v7 offset:0
ds_read_b64_tr_b16 v[20:21], v10 offset:1024
ds_read_b64_tr_b16 v[22:23], v7 offset:1024
v_cvt_pk_bf16_f32 v40, v64, v65
v_cvt_pk_bf16_f32 v41, v66, v67
v_cvt_pk_bf16_f32 v42, v68, v69
v_cvt_pk_bf16_f32 v43, v70, v71
v_cvt_pk_bf16_f32 v44, v72, v73
v_cvt_pk_bf16_f32 v45, v74, v75
v_cvt_pk_bf16_f32 v46, v76, v77
v_cvt_pk_bf16_f32 v47, v78, v79
ds_write_b128 v8, v[40:43]
ds_write_b128 v9, v[44:47]
ds_read_b64_tr_b16 v[24:25], v10 offset:0
ds_read_b64_tr_b16 v[26:27], v7 offset:0
ds_read_b64_tr_b16 v[28:29], v10 offset:1024
ds_read_b64_tr_b16 v[30:31], v7 offset:1024
v_cvt_pk_bf16_f32 v40, v80, v81
v_cvt_pk_bf16_f32 v41, v82, v83
v_cvt_pk_bf16_f32 v42, v84, v85
v_cvt_pk_bf16_f32 v43, v86, v87
v_cvt_pk_bf16_f32 v44, v88, v89
v_cvt_pk_bf16_f32 v45, v90, v91
v_cvt_pk_bf16_f32 v46, v92, v93
v_cvt_pk_bf16_f32 v47, v94, v95
ds_write_b128 v8, v[40:43]
ds_write_b128 v9, v[44:47]
ds_read_b64_tr_b16 v[32:33], v10 offset:0
ds_read_b64_tr_b16 v[34:35], v7 offset:0
ds_read_b64_tr_b16 v[36:37], v10 offset:1024
ds_read_b64_tr_b16 v[38:39], v7 offset:1024
s_waitcnt lgkmcnt(0)
s_lshl_b32 s76, s5, 3
s_add_u32 s76, s76, s6
s_lshl_b32 s76, s76, 2
s_add_u32 s76, s76, s7
s_lshl_b32 s76, s76, 1
s_add_u32 s76, s76, s8
s_mul_i32 s76, s76, 6144
s_add_u32 s76, s76, 3145728
v_lshlrev_b32 v1, 4, v0
s_cmp_eq_u32 s96, 1
s_cbranch_scc1 L_PUBL_2
buffer_store_dwordx4 v[16:19], v1, s[12:15], s76 offen offset:0 sc1
buffer_store_dwordx4 v[20:23], v1, s[12:15], s76 offen offset:1024 sc1
buffer_store_dwordx4 v[24:27], v1, s[12:15], s76 offen offset:2048 sc1
buffer_store_dwordx4 v[28:31], v1, s[12:15], s76 offen offset:3072 sc1
s_add_u32 s76, s76, 4096
buffer_store_dwordx4 v[32:35], v1, s[12:15], s76 offen offset:0 sc1
buffer_store_dwordx4 v[36:39], v1, s[12:15], s76 offen offset:1024 sc1
s_branch L_PUBD_3
L_PUBL_2:
buffer_store_dwordx4 v[16:19], v1, s[12:15], s76 offen offset:0 sc1
buffer_store_dwordx4 v[20:23], v1, s[12:15], s76 offen offset:1024 sc1
buffer_store_dwordx4 v[24:27], v1, s[12:15], s76 offen offset:2048 sc1
buffer_store_dwordx4 v[28:31], v1, s[12:15], s76 offen offset:3072 sc1
s_add_u32 s76, s76, 4096
buffer_store_dwordx4 v[32:35], v1, s[12:15], s76 offen offset:0 sc1
buffer_store_dwordx4 v[36:39], v1, s[12:15], s76 offen offset:1024 sc1
L_PUBD_3:
v_lshlrev_b32 v4, 4, v0
v_lshlrev_b32 v1, 4, v0
v_add_u32 v8, 122880, v4
v_add_u32 v9, 0, v4
s_barrier
ds_read_b128 v[64:67], v8 offset:0
ds_read_b128 v[68:71], v8 offset:1024
ds_read_b128 v[72:75], v8 offset:2048
ds_read_b128 v[76:79], v8 offset:3072
ds_read_b128 v[80:83], v8 offset:4096
s_waitcnt lgkmcnt(4)
v_mfma_f32_32x32x16_bf16 v[88:103], v[64:67], v[16:19], 0
ds_read_b128 v[84:87], v8 offset:5120
s_waitcnt lgkmcnt(4)
v_mfma_f32_32x32x16_bf16 v[104:119], v[68:71], v[16:19], 0
ds_read_b128 v[64:67], v8 offset:6144
s_waitcnt lgkmcnt(4)
v_mfma_f32_32x32x16_bf16 v[120:135], v[72:75], v[16:19], 0
ds_read_b128 v[68:71], v8 offset:7168
s_waitcnt lgkmcnt(4)
v_mfma_f32_32x32x16_bf16 v[136:151], v[76:79], v[16:19], 0
ds_read_b128 v[72:75], v8 offset:8192
s_waitcnt lgkmcnt(4)
v_mfma_f32_32x32x16_bf16 v[152:167], v[80:83], v[16:19], 0
ds_read_b128 v[76:79], v8 offset:9216
s_lshl_b32 s77, s5, 1
s_add_u32 s77, s77, s9
s_lshl_b32 s77, s77, 2
s_add_u32 s77, s77, s7
s_lshl_b32 s77, s77, 1
s_add_u32 s77, s77, s8
s_lshl_b32 s77, s77, 7
s_add_u32 s77, s77, 294912
s_lshl_b32 s76, s10, 2
s_add_u32 s76, s76, s77
s_waitcnt vmcnt(0)
v_mov_b32 v2, s11
s_mov_b64 exec, 1
s_cmp_eq_u32 s96, 1
s_cbranch_scc1 L_FLGL_4
buffer_store_dword v2, off, s[12:15], s76 sc1
s_branch L_FLGD_5
L_FLGL_4:
buffer_store_dword v2, off, s[12:15], s76
L_FLGD_5:
s_mov_b64 exec, -1
s_waitcnt lgkmcnt(4)
v_mfma_f32_32x32x16_bf16 v[88:103], v[84:87], v[20:23], v[88:103]
ds_read_b128 v[80:83], v8 offset:10240
s_waitcnt lgkmcnt(4)
v_mfma_f32_32x32x16_bf16 v[104:119], v[64:67], v[20:23], v[104:119]
ds_read_b128 v[84:87], v8 offset:11264
s_waitcnt lgkmcnt(4)
v_mfma_f32_32x32x16_bf16 v[120:135], v[68:71], v[20:23], v[120:135]
ds_read_b128 v[64:67], v8 offset:12288
s_waitcnt lgkmcnt(4)
v_mfma_f32_32x32x16_bf16 v[136:151], v[72:75], v[20:23], v[136:151]
ds_read_b128 v[68:71], v8 offset:13312
s_waitcnt lgkmcnt(4)
v_mfma_f32_32x32x16_bf16 v[152:167], v[76:79], v[20:23], v[152:167]
ds_read_b128 v[72:75], v8 offset:14336
s_waitcnt lgkmcnt(4)
v_mfma_f32_32x32x16_bf16 v[88:103], v[80:83], v[24:27], v[88:103]
s_waitcnt lgkmcnt(3)
v_mfma_f32_32x32x16_bf16 v[104:119], v[84:87], v[24:27], v[104:119]
s_waitcnt lgkmcnt(0)
s_barrier
v_add_u32 v8, 25600, v4
ds_read_b128 v[76:79], v9 offset:0
ds_read_b128 v[80:83], v9 offset:1024
v_mfma_f32_32x32x16_bf16 v[120:135], v[64:67], v[24:27], v[120:135]
ds_read_b128 v[84:87], v9 offset:2048
v_mfma_f32_32x32x16_bf16 v[136:151], v[68:71], v[24:27], v[136:151]
ds_read_b128 v[64:67], v9 offset:3072
v_mfma_f32_32x32x16_bf16 v[152:167], v[72:75], v[24:27], v[152:167]
ds_read_b128 v[68:71], v9 offset:4096
s_lshl_b32 s79, s5, 1
s_add_u32 s79, s79, s9
s_lshl_b32 s79, s79, 2
s_add_u32 s79, s79, s7
s_lshl_b32 s79, s79, 1
s_add_u32 s79, s79, s8
s_lshl_b32 s79, s79, 7
s_add_u32 s79, s79, 294912
buffer_load_dwordx4 v[12:15], off, s[12:15], s79 sc1
s_add_u32 s73, s10, 1
s_and_b32 s73, s73, 3
s_lshl_b32 s74, s9, 2
s_add_u32 s73, s73, s74
s_lshl_b32 s84, s5, 3
s_add_u32 s84, s84, s73
s_lshl_b32 s84, s84, 2
s_add_u32 s84, s84, s7
s_lshl_b32 s84, s84, 1
s_add_u32 s84, s84, s8
s_mul_i32 s84, s84, 6144
s_add_u32 s84, s84, 3145728
s_add_u32 s87, s84, 4096
s_add_u32 s73, s10, 2
s_and_b32 s73, s73, 3
s_lshl_b32 s74, s9, 2
s_add_u32 s73, s73, s74
s_lshl_b32 s85, s5, 3
s_add_u32 s85, s85, s73
s_lshl_b32 s85, s85, 2
s_add_u32 s85, s85, s7
s_lshl_b32 s85, s85, 1
s_add_u32 s85, s85, s8
s_mul_i32 s85, s85, 6144
s_add_u32 s85, s85, 3145728
s_add_u32 s88, s85, 4096
s_add_u32 s73, s10, 3
s_and_b32 s73, s73, 3
s_lshl_b32 s74, s9, 2
s_add_u32 s73, s73, s74
s_lshl_b32 s86, s5, 3
s_add_u32 s86, s86, s73
s_lshl_b32 s86, s86, 2
s_add_u32 s86, s86, s7
s_lshl_b32 s86, s86, 1
s_add_u32 s86, s86, s8
s_mul_i32 s86, s86, 6144
s_add_u32 s86, s86, 3145728
s_add_u32 s89, s86, 4096
s_waitcnt lgkmcnt(4)
v_mfma_f32_32x32x16_bf16 v[88:103], v[76:79], v[28:31], v[88:103]
ds_read_b128 v[72:75], v9 offset:5120
s_add_u32 s81, s9, 0
s_lshl_b32 s82, s5, 7
s_lshl_b32 s83, s81, 5
s_add_u32 s82, s82, s83
v_and_b32 v2, 31, v0
v_add_u32 v2, s82, v2
v_lshrrev_b32 v3, 5, v0
v_lshlrev_b32 v3, 3, v3
v_mul_u32_u24 v6, 1280, v2
v_add_u32 v6, v6, v3
s_add_u32 s82, s3, 0
s_min_u32 s82, s82, 9
s_lshr_b32 s83, s82, 1
s_lshl_b32 s83, s83, 6
s_and_b32 s82, s82, 1
s_lshl_b32 s82, s82, 5
s_add_u32 s90, s82, s83
s_add_u32 s82, s3, 8
s_min_u32 s82, s82, 9
s_lshr_b32 s83, s82, 1
s_lshl_b32 s83, s83, 6
s_and_b32 s82, s82, 1
s_lshl_b32 s82, s82, 5
s_add_u32 s91, s82, s83
s_mul_i32 s92, s10, 320
s_waitcnt lgkmcnt(4)
v_mfma_f32_32x32x16_bf16 v[104:119], v[80:83], v[28:31], v[104:119]
ds_read_b128 v[76:79], v9 offset:6144
s_waitcnt lgkmcnt(4)
v_mfma_f32_32x32x16_bf16 v[120:135], v[84:87], v[28:31], v[120:135]
ds_read_b128 v[80:83], v9 offset:7168
s_waitcnt lgkmcnt(4)
v_mfma_f32_32x32x16_bf16 v[136:151], v[64:67], v[28:31], v[136:151]
ds_read_b128 v[84:87], v9 offset:8192
s_waitcnt lgkmcnt(4)
v_mfma_f32_32x32x16_bf16 v[152:167], v[68:71], v[28:31], v[152:167]
ds_read_b128 v[64:67], v9 offset:9216
s_waitcnt vmcnt(0)
s_mov_b32 s80, 65536
L_PF1_S0:
v_xor_b32 v12, s11, v12
v_xor_b32 v13, s11, v13
v_xor_b32 v14, s11, v14
v_xor_b32 v15, s11, v15
v_or3_b32 v12, v12, v13, v14
v_or_b32 v12, v12, v15
v_cmp_ne_u32 vcc, 0, v12
s_cbranch_vccz L_PF1_S0_ok
s_sub_u32 s80, s80, 1
s_cmp_eq_u32 s80, 0
s_cbranch_scc1 L_PF1_S0_ok
buffer_load_dwordx4 v[12:15], off, s[12:15], s79 sc1
s_waitcnt vmcnt(0)
s_branch L_PF1_S0
L_PF1_S0_ok:
buffer_load_dwordx4 v[40:43], v1, s[12:15], s84 offen offset:0
s_waitcnt lgkmcnt(4)
v_mfma_f32_32x32x16_bf16 v[88:103], v[72:75], v[32:35], v[88:103]
ds_read_b128 v[68:71], v9 offset:10240
s_waitcnt lgkmcnt(4)
v_mfma_f32_32x32x16_bf16 v[104:119], v[76:79], v[32:35], v[104:119]
ds_read_b128 v[72:75], v9 offset:11264
s_waitcnt lgkmcnt(4)
v_mfma_f32_32x32x16_bf16 v[120:135], v[80:83], v[32:35], v[120:135]
ds_read_b128 v[76:79], v9 offset:12288
buffer_load_dwordx4 v[44:47], v1, s[12:15], s84 offen offset:1024
s_waitcnt lgkmcnt(4)
v_mfma_f32_32x32x16_bf16 v[136:151], v[84:87], v[32:35], v[136:151]
ds_read_b128 v[80:83], v9 offset:13312
s_waitcnt lgkmcnt(4)
v_mfma_f32_32x32x16_bf16 v[152:167], v[64:67], v[32:35], v[152:167]
ds_read_b128 v[84:87], v9 offset:14336
s_waitcnt lgkmcnt(4)
v_mfma_f32_32x32x16_bf16 v[88:103], v[68:71], v[36:39], v[88:103]
buffer_load_dwordx4 v[48:51], v1, s[12:15], s84 offen offset:2048
s_waitcnt lgkmcnt(3)
v_mfma_f32_32x32x16_bf16 v[104:119], v[72:75], v[36:39], v[104:119]
s_waitcnt lgkmcnt(0)
s_barrier
v_add_u32 v9, 51200, v4
ds_read_b128 v[64:67], v8 offset:0
ds_read_b128 v[68:71], v8 offset:1024
v_mfma_f32_32x32x16_bf16 v[120:135], v[76:79], v[36:39], v[120:135]
ds_read_b128 v[72:75], v8 offset:2048
v_mfma_f32_32x32x16_bf16 v[136:151], v[80:83], v[36:39], v[136:151]
ds_read_b128 v[76:79], v8 offset:3072
buffer_load_dwordx4 v[52:55], v1, s[12:15], s84 offen offset:3072
v_mfma_f32_32x32x16_bf16 v[152:167], v[84:87], v[36:39], v[152:167]
ds_read_b128 v[80:83], v8 offset:4096
s_waitcnt vmcnt(3)
s_waitcnt lgkmcnt(4)
v_mfma_f32_32x32x16_bf16 v[88:103], v[64:67], v[40:43], v[88:103]
ds_read_b128 v[84:87], v8 offset:5120
s_waitcnt lgkmcnt(4)
v_mfma_f32_32x32x16_bf16 v[104:119], v[68:71], v[40:43], v[104:119]
ds_read_b128 v[64:67], v8 offset:6144
buffer_load_dwordx4 v[56:59], v1, s[12:15], s87 offen offset:0
s_waitcnt lgkmcnt(4)
v_mfma_f32_32x32x16_bf16 v[120:135], v[72:75], v[40:43], v[120:135]
ds_read_b128 v[68:71], v8 offset:7168
s_waitcnt lgkmcnt(4)
v_mfma_f32_32x32x16_bf16 v[136:151], v[76:79], v[40:43], v[136:151]
ds_read_b128 v[72:75], v8 offset:8192
s_waitcnt lgkmcnt(4)
v_mfma_f32_32x32x16_bf16 v[152:167], v[80:83], v[40:43], v[152:167]
ds_read_b128 v[76:79], v8 offset:9216
buffer_load_dwordx4 v[60:63], v1, s[12:15], s87 offen offset:1024
s_waitcnt vmcnt(4)
s_waitcnt lgkmcnt(4)
v_mfma_f32_32x32x16_bf16 v[88:103], v[84:87], v[44:47], v[88:103]
ds_read_b128 v[80:83], v8 offset:10240
s_waitcnt lgkmcnt(4)
v_mfma_f32_32x32x16_bf16 v[104:119], v[64:67], v[44:47], v[104:119]
ds_read_b128 v[84:87], v8 offset:11264
s_waitcnt lgkmcnt(4)
v_mfma_f32_32x32x16_bf16 v[120:135], v[68:71], v[44:47], v[120:135]
ds_read_b128 v[64:67], v8 offset:12288
buffer_load_dwordx4 v[16:19], v1, s[12:15], s85 offen offset:0
s_waitcnt lgkmcnt(4)
v_mfma_f32_32x32x16_bf16 v[136:151], v[72:75], v[44:47], v[136:151]
ds_read_b128 v[68:71], v8 offset:13312
s_waitcnt lgkmcnt(4)
v_mfma_f32_32x32x16_bf16 v[152:167], v[76:79], v[44:47], v[152:167]
ds_read_b128 v[72:75], v8 offset:14336
s_waitcnt vmcnt(4)
s_waitcnt lgkmcnt(4)
v_mfma_f32_32x32x16_bf16 v[88:103], v[80:83], v[48:51], v[88:103]
buffer_load_dwordx4 v[20:23], v1, s[12:15], s85 offen offset:1024
s_waitcnt lgkmcnt(3)
v_mfma_f32_32x32x16_bf16 v[104:119], v[84:87], v[48:51], v[104:119]
s_waitcnt lgkmcnt(0)
s_barrier
v_add_u32 v8, 76800, v4
ds_read_b128 v[76:79], v9 offset:0
ds_read_b128 v[80:83], v9 offset:1024
v_mfma_f32_32x32x16_bf16 v[120:135], v[64:67], v[48:51], v[120:135]
ds_read_b128 v[84:87], v9 offset:2048
v_mfma_f32_32x32x16_bf16 v[136:151], v[68:71], v[48:51], v[136:151]
ds_read_b128 v[64:67], v9 offset:3072
buffer_load_dwordx4 v[24:27], v1, s[12:15], s85 offen offset:2048
v_mfma_f32_32x32x16_bf16 v[152:167], v[72:75], v[48:51], v[152:167]
ds_read_b128 v[68:71], v9 offset:4096
s_waitcnt vmcnt(5)
s_waitcnt lgkmcnt(4)
v_mfma_f32_32x32x16_bf16 v[88:103], v[76:79], v[52:55], v[88:103]
ds_read_b128 v[72:75], v9 offset:5120
s_waitcnt lgkmcnt(4)
v_mfma_f32_32x32x16_bf16 v[104:119], v[80:83], v[52:55], v[104:119]
ds_read_b128 v[76:79], v9 offset:6144
buffer_load_dwordx4 v[28:31], v1, s[12:15], s85 offen offset:3072
s_waitcnt lgkmcnt(4)
v_mfma_f32_32x32x16_bf16 v[120:135], v[84:87], v[52:55], v[120:135]
ds_read_b128 v[80:83], v9 offset:7168
s_waitcnt lgkmcnt(4)
v_mfma_f32_32x32x16_bf16 v[136:151], v[64:67], v[52:55], v[136:151]
ds_read_b128 v[84:87], v9 offset:8192
s_waitcnt lgkmcnt(4)
v_mfma_f32_32x32x16_bf16 v[152:167], v[68:71], v[52:55], v[152:167]
ds_read_b128 v[64:67], v9 offset:9216
buffer_load_dwordx4 v[32:35], v1, s[12:15], s88 offen offset:0
s_waitcnt vmcnt(6)
s_waitcnt lgkmcnt(4)
v_mfma_f32_32x32x16_bf16 v[88:103], v[72:75], v[56:59], v[88:103]
ds_read_b128 v[68:71], v9 offset:10240
s_waitcnt lgkmcnt(4)
v_mfma_f32_32x32x16_bf16 v[104:119], v[76:79], v[56:59], v[104:119]
ds_read_b128 v[72:75], v9 offset:11264
s_waitcnt lgkmcnt(4)
v_mfma_f32_32x32x16_bf16 v[120:135], v[80:83], v[56:59], v[120:135]
ds_read_b128 v[76:79], v9 offset:12288
buffer_load_dwordx4 v[36:39], v1, s[12:15], s88 offen offset:1024
s_waitcnt lgkmcnt(4)
v_mfma_f32_32x32x16_bf16 v[136:151], v[84:87], v[56:59], v[136:151]
ds_read_b128 v[80:83], v9 offset:13312
s_waitcnt lgkmcnt(4)
v_mfma_f32_32x32x16_bf16 v[152:167], v[64:67], v[56:59], v[152:167]
ds_read_b128 v[84:87], v9 offset:14336
s_waitcnt vmcnt(6)
s_waitcnt lgkmcnt(4)
v_mfma_f32_32x32x16_bf16 v[88:103], v[68:71], v[60:63], v[88:103]
buffer_load_dwordx4 v[40:43], v1, s[12:15], s86 offen offset:0
s_waitcnt lgkmcnt(3)
v_mfma_f32_32x32x16_bf16 v[104:119], v[72:75], v[60:63], v[104:119]
s_waitcnt lgkmcnt(0)
s_barrier
v_add_u32 v9, 122880, v4
ds_read_b128 v[64:67], v8 offset:0
ds_read_b128 v[68:71], v8 offset:1024
v_mfma_f32_32x32x16_bf16 v[120:135], v[76:79], v[60:63], v[120:135]
ds_read_b128 v[72:75], v8 offset:2048
v_mfma_f32_32x32x16_bf16 v[136:151], v[80:83], v[60:63], v[136:151]
ds_read_b128 v[76:79], v8 offset:3072
buffer_load_dwordx4 v[44:47], v1, s[12:15], s86 offen offset:1024
v_mfma_f32_32x32x16_bf16 v[152:167], v[84:87], v[60:63], v[152:167]
ds_read_b128 v[80:83], v8 offset:4096
s_waitcnt vmcnt(7)
s_waitcnt lgkmcnt(4)
v_mfma_f32_32x32x16_bf16 v[88:103], v[64:67], v[16:19], v[88:103]
ds_read_b128 v[84:87], v8 offset:5120
s_waitcnt lgkmcnt(4)
v_mfma_f32_32x32x16_bf16 v[104:119], v[68:71], v[16:19], v[104:119]
ds_read_b128 v[64:67], v8 offset:6144
buffer_load_dwordx4 v[48:51], v1, s[12:15], s86 offen offset:2048
s_waitcnt lgkmcnt(4)
v_mfma_f32_32x32x16_bf16 v[120:135], v[72:75], v[16:19], v[120:135]
ds_read_b128 v[68:71], v8 offset:7168
s_waitcnt lgkmcnt(4)
v_mfma_f32_32x32x16_bf16 v[136:151], v[76:79], v[16:19], v[136:151]
ds_read_b128 v[72:75], v8 offset:8192
s_waitcnt lgkmcnt(4)
v_mfma_f32_32x32x16_bf16 v[152:167], v[80:83], v[16:19], v[152:167]
ds_read_b128 v[76:79], v8 offset:9216
buffer_load_dwordx4 v[52:55], v1, s[12:15], s86 offen offset:3072
s_waitcnt vmcnt(8)
s_waitcnt lgkmcnt(4)
v_mfma_f32_32x32x16_bf16 v[88:103], v[84:87], v[20:23], v[88:103]
ds_read_b128 v[80:83], v8 offset:10240
s_waitcnt lgkmcnt(4)
v_mfma_f32_32x32x16_bf16 v[104:119], v[64:67], v[20:23], v[104:119]
ds_read_b128 v[84:87], v8 offset:11264
s_waitcnt lgkmcnt(4)
v_mfma_f32_32x32x16_bf16 v[120:135], v[68:71], v[20:23], v[120:135]
ds_read_b128 v[64:67], v8 offset:12288
buffer_load_dwordx4 v[56:59], v1, s[12:15], s89 offen offset:0
s_waitcnt lgkmcnt(4)
v_mfma_f32_32x32x16_bf16 v[136:151], v[72:75], v[20:23], v[136:151]
ds_read_b128 v[68:71], v8 offset:13312
s_waitcnt lgkmcnt(4)
v_mfma_f32_32x32x16_bf16 v[152:167], v[76:79], v[20:23], v[152:167]
ds_read_b128 v[72:75], v8 offset:14336
s_waitcnt vmcnt(8)
s_waitcnt lgkmcnt(4)
v_mfma_f32_32x32x16_bf16 v[88:103], v[80:83], v[24:27], v[88:103]
buffer_load_dwordx4 v[60:63], v1, s[12:15], s89 offen offset:1024
s_waitcnt lgkmcnt(3)
v_mfma_f32_32x32x16_bf16 v[104:119], v[84:87], v[24:27], v[104:119]
s_waitcnt lgkmcnt(0)
s_barrier
v_add_u32 v8, 0, v4
ds_read_b128 v[76:79], v9 offset:0
ds_read_b128 v[80:83], v9 offset:1024
v_mfma_f32_32x32x16_bf16 v[120:135], v[64:67], v[24:27], v[120:135]
ds_read_b128 v[84:87], v9 offset:2048
v_mfma_f32_32x32x16_bf16 v[136:151], v[68:71], v[24:27], v[136:151]
ds_read_b128 v[64:67], v9 offset:3072
v_mfma_f32_32x32x16_bf16 v[152:167], v[72:75], v[24:27], v[152:167]
ds_read_b128 v[68:71], v9 offset:4096
s_waitcnt vmcnt(8)
s_waitcnt lgkmcnt(4)
v_mfma_f32_32x32x16_bf16 v[88:103], v[76:79], v[28:31], v[88:103]
ds_read_b128 v[72:75], v9 offset:5120
s_waitcnt lgkmcnt(4)
v_mfma_f32_32x32x16_bf16 v[104:119], v[80:83], v[28:31], v[104:119]
ds_read_b128 v[76:79], v9 offset:6144
s_waitcnt lgkmcnt(4)
v_mfma_f32_32x32x16_bf16 v[120:135], v[84:87], v[28:31], v[120:135]
ds_read_b128 v[80:83], v9 offset:7168
s_waitcnt lgkmcnt(4)
v_mfma_f32_32x32x16_bf16 v[136:151], v[64:67], v[28:31], v[136:151]
ds_read_b128 v[84:87], v9 offset:8192
s_waitcnt lgkmcnt(4)
v_mfma_f32_32x32x16_bf16 v[152:167], v[68:71], v[28:31], v[152:167]
ds_read_b128 v[64:67], v9 offset:9216
s_waitcnt vmcnt(7)
s_waitcnt lgkmcnt(4)
v_mfma_f32_32x32x16_bf16 v[88:103], v[72:75], v[32:35], v[88:103]
ds_read_b128 v[68:71], v9 offset:10240
s_waitcnt lgkmcnt(4)
v_mfma_f32_32x32x16_bf16 v[104:119], v[76:79], v[32:35], v[104:119]
ds_read_b128 v[72:75], v9 offset:11264
s_waitcnt lgkmcnt(4)
v_mfma_f32_32x32x16_bf16 v[120:135], v[80:83], v[32:35], v[120:135]
ds_read_b128 v[76:79], v9 offset:12288
s_waitcnt lgkmcnt(4)
v_mfma_f32_32x32x16_bf16 v[136:151], v[84:87], v[32:35], v[136:151]
ds_read_b128 v[80:83], v9 offset:13312
s_waitcnt lgkmcnt(4)
v_mfma_f32_32x32x16_bf16 v[152:167], v[64:67], v[32:35], v[152:167]
ds_read_b128 v[84:87], v9 offset:14336
s_waitcnt vmcnt(6)
s_waitcnt lgkmcnt(4)
v_mfma_f32_32x32x16_bf16 v[88:103], v[68:71], v[36:39], v[88:103]
s_waitcnt lgkmcnt(3)
v_mfma_f32_32x32x16_bf16 v[104:119], v[72:75], v[36:39], v[104:119]
s_waitcnt lgkmcnt(0)
s_barrier
v_add_u32 v9, 25600, v4
ds_read_b128 v[64:67], v8 offset:0
ds_read_b128 v[68:71], v8 offset:1024
v_mfma_f32_32x32x16_bf16 v[120:135], v[76:79], v[36:39], v[120:135]
ds_read_b128 v[72:75], v8 offset:2048
v_mfma_f32_32x32x16_bf16 v[136:151], v[80:83], v[36:39], v[136:151]
ds_read_b128 v[76:79], v8 offset:3072
v_mfma_f32_32x32x16_bf16 v[152:167], v[84:87], v[36:39], v[152:167]
ds_read_b128 v[80:83], v8 offset:4096
s_add_u32 s82, s92, s90
buffer_load_dwordx2 v[16:17], v6, s[16:19], s82 offen offset:0
buffer_load_dwordx2 v[18:19], v6, s[16:19], s82 offen offset:16
s_cmp_ge_u32 s3, 2
s_cbranch_scc1 L_FXL_S0
s_add_u32 s82, s92, s91
buffer_load_dwordx2 v[20:21], v6, s[16:19], s82 offen offset:0
buffer_load_dwordx2 v[22:23], v6, s[16:19], s82 offen offset:16
L_FXL_S0:
s_waitcnt vmcnt(5)
s_waitcnt lgkmcnt(4)
v_mfma_f32_32x32x16_bf16 v[88:103], v[64:67], v[40:43], v[88:103]
ds_read_b128 v[84:87], v8 offset:5120
s_waitcnt lgkmcnt(4)
v_mfma_f32_32x32x16_bf16 v[104:119], v[68:71], v[40:43], v[104:119]
ds_read_b128 v[64:67], v8 offset:6144
s_waitcnt lgkmcnt(4)
v_mfma_f32_32x32x16_bf16 v[120:135], v[72:75], v[40:43], v[120:135]
ds_read_b128 v[68:71], v8 offset:7168
s_waitcnt lgkmcnt(4)
v_mfma_f32_32x32x16_bf16 v[136:151], v[76:79], v[40:43], v[136:151]
ds_read_b128 v[72:75], v8 offset:8192
s_waitcnt lgkmcnt(4)
v_mfma_f32_32x32x16_bf16 v[152:167], v[80:83], v[40:43], v[152:167]
ds_read_b128 v[76:79], v8 offset:9216
s_waitcnt vmcnt(4)
s_waitcnt lgkmcnt(4)
v_mfma_f32_32x32x16_bf16 v[88:103], v[84:87], v[44:47], v[88:103]
ds_read_b128 v[80:83], v8 offset:10240
s_waitcnt lgkmcnt(4)
v_mfma_f32_32x32x16_bf16 v[104:119], v[64:67], v[44:47], v[104:119]
ds_read_b128 v[84:87], v8 offset:11264
s_waitcnt lgkmcnt(4)
v_mfma_f32_32x32x16_bf16 v[120:135], v[68:71], v[44:47], v[120:135]
ds_read_b128 v[64:67], v8 offset:12288
s_waitcnt lgkmcnt(4)
v_mfma_f32_32x32x16_bf16 v[136:151], v[72:75], v[44:47], v[136:151]
ds_read_b128 v[68:71], v8 offset:13312
s_waitcnt lgkmcnt(4)
v_mfma_f32_32x32x16_bf16 v[152:167], v[76:79], v[44:47], v[152:167]
ds_read_b128 v[72:75], v8 offset:14336
s_waitcnt vmcnt(3)
s_waitcnt lgkmcnt(4)
v_mfma_f32_32x32x16_bf16 v[88:103], v[80:83], v[48:51], v[88:103]
s_waitcnt lgkmcnt(3)
v_mfma_f32_32x32x16_bf16 v[104:119], v[84:87], v[48:51], v[104:119]
s_waitcnt lgkmcnt(0)
s_barrier
ds_read_b128 v[76:79], v9 offset:0
ds_read_b128 v[80:83], v9 offset:1024
v_mfma_f32_32x32x16_bf16 v[120:135], v[64:67], v[48:51], v[120:135]
ds_read_b128 v[84:87], v9 offset:2048
v_mfma_f32_32x32x16_bf16 v[136:151], v[68:71], v[48:51], v[136:151]
ds_read_b128 v[64:67], v9 offset:3072
v_mfma_f32_32x32x16_bf16 v[152:167], v[72:75], v[48:51], v[152:167]
ds_read_b128 v[68:71], v9 offset:4096
s_waitcnt vmcnt(2)
s_waitcnt lgkmcnt(4)
v_mfma_f32_32x32x16_bf16 v[88:103], v[76:79], v[52:55], v[88:103]
ds_read_b128 v[72:75], v9 offset:5120
s_waitcnt lgkmcnt(4)
v_mfma_f32_32x32x16_bf16 v[104:119], v[80:83], v[52:55], v[104:119]
ds_read_b128 v[76:79], v9 offset:6144
s_waitcnt lgkmcnt(4)
v_mfma_f32_32x32x16_bf16 v[120:135], v[84:87], v[52:55], v[120:135]
ds_read_b128 v[80:83], v9 offset:7168
s_waitcnt lgkmcnt(4)
v_mfma_f32_32x32x16_bf16 v[136:151], v[64:67], v[52:55], v[136:151]
ds_read_b128 v[84:87], v9 offset:8192
s_waitcnt lgkmcnt(4)
v_mfma_f32_32x32x16_bf16 v[152:167], v[68:71], v[52:55], v[152:167]
ds_read_b128 v[64:67], v9 offset:9216
s_waitcnt vmcnt(1)
s_waitcnt lgkmcnt(4)
v_mfma_f32_32x32x16_bf16 v[88:103], v[72:75], v[56:59], v[88:103]
ds_read_b128 v[68:71], v9 offset:10240
s_waitcnt lgkmcnt(4)
v_mfma_f32_32x32x16_bf16 v[104:119], v[76:79], v[56:59], v[104:119]
ds_read_b128 v[72:75], v9 offset:11264
s_waitcnt lgkmcnt(4)
v_mfma_f32_32x32x16_bf16 v[120:135], v[80:83], v[56:59], v[120:135]
ds_read_b128 v[76:79], v9 offset:12288
s_waitcnt lgkmcnt(4)
v_mfma_f32_32x32x16_bf16 v[136:151], v[84:87], v[56:59], v[136:151]
ds_read_b128 v[80:83], v9 offset:13312
s_waitcnt lgkmcnt(4)
v_mfma_f32_32x32x16_bf16 v[152:167], v[64:67], v[56:59], v[152:167]
ds_read_b128 v[84:87], v9 offset:14336
s_waitcnt vmcnt(0)
s_waitcnt lgkmcnt(4)
v_mfma_f32_32x32x16_bf16 v[88:103], v[68:71], v[60:63], v[88:103]
s_waitcnt lgkmcnt(3)
v_mfma_f32_32x32x16_bf16 v[104:119], v[72:75], v[60:63], v[104:119]
s_waitcnt lgkmcnt(0)
s_barrier
v_mfma_f32_32x32x16_bf16 v[120:135], v[76:79], v[60:63], v[120:135]
v_mfma_f32_32x32x16_bf16 v[136:151], v[80:83], v[60:63], v[136:151]
v_mfma_f32_32x32x16_bf16 v[152:167], v[84:87], v[60:63], v[152:167]
s_branch L_FIN_S
L_CS1:
s_waitcnt lgkmcnt(0)
s_barrier
ds_read_b128 v[16:19], v4
ds_read_b128 v[20:23], v8 offset:0
ds_read_b128 v[24:27], v8 offset:4096
s_mov_b32 s70, 0
s_mov_b32 s71, 2
L_P1_S1:
s_waitcnt lgkmcnt(0)
v_mfma_f32_32x32x16_bf16 v[48:63], v[16:19], v[20:23], v[48:63]
ds_read_b128 v[32:35], v5
ds_read_b128 v[36:39], v9 offset:0
ds_read_b128 v[40:43], v9 offset:4096
v_mfma_f32_32x32x16_bf16 v[64:79], v[16:19], v[24:27], v[64:79]
s_waitcnt lgkmcnt(0)
v_mfma_f32_32x32x16_bf16 v[48:63], v[32:35], v[36:39], v[48:63]
ds_read_b128 v[16:19], v6
ds_read_b128 v[20:23], v10 offset:0
ds_read_b128 v[24:27], v10 offset:4096
v_mfma_f32_32x32x16_bf16 v[64:79], v[32:35], v[40:43], v[64:79]
s_waitcnt lgkmcnt(0)
v_mfma_f32_32x32x16_bf16 v[48:63], v[16:19], v[20:23], v[48:63]
ds_read_b128 v[32:35], v7
ds_read_b128 v[36:39], v11 offset:0
ds_read_b128 v[40:43], v11 offset:4096
v_mfma_f32_32x32x16_bf16 v[64:79], v[16:19], v[24:27], v[64:79]
s_mov_b32 s72, 40960
s_cmp_eq_u32 s71, 2
s_cselect_b32 s72, 4294885376, s72
s_cselect_b32 s71, -1, s71
s_add_u32 s71, s71, 1
v_add_u32 v4, s72, v4
v_add_u32 v5, s72, v5
v_add_u32 v6, s72, v6
v_add_u32 v7, s72, v7
v_add_u32 v8, s72, v8
v_add_u32 v9, s72, v9
v_add_u32 v10, s72, v10
v_add_u32 v11, s72, v11
s_waitcnt lgkmcnt(0)
v_mfma_f32_32x32x16_bf16 v[48:63], v[32:35], v[36:39], v[48:63]
s_cmp_eq_u32 s70, 9
s_cbranch_scc1 L_P1_S1_last
s_cmp_lg_u32 s70, 3
s_cbranch_scc1 L_P1_S1_nw
s_waitcnt vmcnt(0)
L_P1_S1_nw:
s_barrier
s_cmp_lg_u32 s70, 3
s_cbranch_scc1 L_P1_S1_nf
s_cmp_lg_u32 s3, 0
s_cbranch_scc1 L_P1_S1_nf
v_mov_b32 v2, s11
s_lshl_b32 s73, s2, 2
s_add_u32 s73, s73, 4096
s_mov_b64 exec, 1
buffer_store_dword v2, off, s[12:15], s73 sc1
s_mov_b64 exec, -1
L_P1_S1_nf:
ds_read_b128 v[16:19], v4
ds_read_b128 v[20:23], v8 offset:0
v_mfma_f32_32x32x16_bf16 v[64:79], v[32:35], v[40:43], v[64:79]
ds_read_b128 v[24:27], v8 offset:4096
s_add_u32 s70, s70, 1
s_branch L_P1_S1
L_P1_S1_last:
v_mfma_f32_32x32x16_bf16 v[64:79], v[32:35], v[40:43], v[64:79]
s_barrier
v_mov_b32 v12, 163712
ds_read_b32 v2, v12
v_and_b32 v12, 3, v0
v_bfe_u32 v13, v0, 2, 1
v_lshl_add_u32 v12, v13, 4, v12
v_bfe_u32 v13, v0, 3, 2
v_lshl_add_u32 v12, v13, 2, v12
s_lshl_b32 s73, s7, 5
v_add_u32 v13, s73, v12
v_lshlrev_b32 v13, 4, v13
v_add_u32 v13, 153600, v13
v_mov_b32 v14, 155648
v_cmp_gt_u32 vcc, 32, v0
s_nop 1
v_cndmask_b32 v13, v14, v13, vcc
ds_read_b128 v[16:19], v13
v_and_b32 v12, 31, v0
s_mul_i32 s73, s8, 96
v_add_u32 v11, s73, v12
v_lshlrev_b32 v12, 4, v11
v_add_u32 v12, 155904, v12
ds_read_b128 v[20:23], v12 offset:0
ds_read_b128 v[24:27], v12 offset:512
v_lshlrev_b32 v14, 4, v11
v_add_u32 v14, 160000, v14
ds_read_b128 v[96:99], v14 offset:0
ds_read_b128 v[100:103], v14 offset:512
v_lshrrev_b32 v13, 5, v0
v_lshlrev_b32 v13, 6, v13
s_lshl_b32 s73, s7, 7
s_add_u32 s73, s73, 163200
v_add_u32 v13, s73, v13
ds_read_b128 v[32:35], v13 offset:0
ds_read_b128 v[36:39], v13 offset:16
ds_read_b128 v[40:43], v13 offset:32
ds_read_b128 v[44:47], v13 offset:48
s_waitcnt lgkmcnt(4)
v_readfirstlane_b32 s96, v2
v_mfma_f32_32x32x16_bf16 v[48:63], v[16:19], v[20:23], v[48:63]
v_mfma_f32_32x32x16_bf16 v[64:79], v[16:19], v[24:27], v[64:79]
s_waitcnt lgkmcnt(0)
s_nop 9
v_pk_mul_f32 v[48:49], v[48:49], v[32:33]
v_pk_mul_f32 v[50:51], v[50:51], v[34:35]
v_pk_mul_f32 v[52:53], v[52:53], v[36:37]
v_pk_mul_f32 v[54:55], v[54:55], v[38:39]
v_pk_mul_f32 v[56:57], v[56:57], v[40:41]
v_pk_mul_f32 v[58:59], v[58:59], v[42:43]
v_pk_mul_f32 v[60:61], v[60:61], v[44:45]
v_pk_mul_f32 v[62:63], v[62:63], v[46:47]
v_pk_mul_f32 v[64:65], v[64:65], v[32:33]
v_pk_mul_f32 v[66:67], v[66:67], v[34:35]
v_pk_mul_f32 v[68:69], v[68:69], v[36:37]
v_pk_mul_f32 v[70:71], v[70:71], v[38:39]
v_pk_mul_f32 v[72:73], v[72:73], v[40:41]
v_pk_mul_f32 v[74:75], v[74:75], v[42:43]
v_pk_mul_f32 v[76:77], v[76:77], v[44:45]
v_pk_mul_f32 v[78:79], v[78:79], v[46:47]
v_mul_f32_dpp v16, v48, v99 quad_perm:[1,0,3,2] row_mask:0xf bank_mask:0xf
v_mul_f32_dpp v17, v64, v103 quad_perm:[1,0,3,2] row_mask:0xf bank_mask:0xf
v_fma_f32 v48, v48, v98, v16
v_fma_f32 v64, v64, v102, v17
v_mul_f32_dpp v16, v49, v99 quad_perm:[1,0,3,2] row_mask:0xf bank_mask:0xf
v_mul_f32_dpp v17, v65, v103 quad_perm:[1,0,3,2] row_mask:0xf bank_mask:0xf
v_fma_f32 v49, v49, v98, v16
v_fma_f32 v65, v65, v102, v17
v_mul_f32_dpp v16, v50, v99 quad_perm:[1,0,3,2] row_mask:0xf bank_mask:0xf
v_mul_f32_dpp v17, v66, v103 quad_perm:[1,0,3,2] row_mask:0xf bank_mask:0xf
v_fma_f32 v50, v50, v98, v16
v_fma_f32 v66, v66, v102, v17
v_mul_f32_dpp v16, v51, v99 quad_perm:[1,0,3,2] row_mask:0xf bank_mask:0xf
v_mul_f32_dpp v17, v67, v103 quad_perm:[1,0,3,2] row_mask:0xf bank_mask:0xf
v_fma_f32 v51, v51, v98, v16
v_fma_f32 v67, v67, v102, v17
v_mul_f32_dpp v16, v52, v99 quad_perm:[1,0,3,2] row_mask:0xf bank_mask:0xf
v_mul_f32_dpp v17, v68, v103 quad_perm:[1,0,3,2] row_mask:0xf bank_mask:0xf
v_fma_f32 v52, v52, v98, v16
v_fma_f32 v68, v68, v102, v17
v_mul_f32_dpp v16, v53, v99 quad_perm:[1,0,3,2] row_mask:0xf bank_mask:0xf
v_mul_f32_dpp v17, v69, v103 quad_perm:[1,0,3,2] row_mask:0xf bank_mask:0xf
v_fma_f32 v53, v53, v98, v16
v_fma_f32 v69, v69, v102, v17
v_mul_f32_dpp v16, v54, v99 quad_perm:[1,0,3,2] row_mask:0xf bank_mask:0xf
v_mul_f32_dpp v17, v70, v103 quad_perm:[1,0,3,2] row_mask:0xf bank_mask:0xf
v_fma_f32 v54, v54, v98, v16
v_fma_f32 v70, v70, v102, v17
v_mul_f32_dpp v16, v55, v99 quad_perm:[1,0,3,2] row_mask:0xf bank_mask:0xf
v_mul_f32_dpp v17, v71, v103 quad_perm:[1,0,3,2] row_mask:0xf bank_mask:0xf
v_fma_f32 v55, v55, v98, v16
v_fma_f32 v71, v71, v102, v17
v_mul_f32_dpp v16, v56, v99 quad_perm:[1,0,3,2] row_mask:0xf bank_mask:0xf
v_mul_f32_dpp v17, v72, v103 quad_perm:[1,0,3,2] row_mask:0xf bank_mask:0xf
v_fma_f32 v56, v56, v98, v16
v_fma_f32 v72, v72, v102, v17
v_mul_f32_dpp v16, v57, v99 quad_perm:[1,0,3,2] row_mask:0xf bank_mask:0xf
v_mul_f32_dpp v17, v73, v103 quad_perm:[1,0,3,2] row_mask:0xf bank_mask:0xf
v_fma_f32 v57, v57, v98, v16
v_fma_f32 v73, v73, v102, v17
v_mul_f32_dpp v16, v58, v99 quad_perm:[1,0,3,2] row_mask:0xf bank_mask:0xf
v_mul_f32_dpp v17, v74, v103 quad_perm:[1,0,3,2] row_mask:0xf bank_mask:0xf
v_fma_f32 v58, v58, v98, v16
v_fma_f32 v74, v74, v102, v17
v_mul_f32_dpp v16, v59, v99 quad_perm:[1,0,3,2] row_mask:0xf bank_mask:0xf
v_mul_f32_dpp v17, v75, v103 quad_perm:[1,0,3,2] row_mask:0xf bank_mask:0xf
v_fma_f32 v59, v59, v98, v16
v_fma_f32 v75, v75, v102, v17
v_mul_f32_dpp v16, v60, v99 quad_perm:[1,0,3,2] row_mask:0xf bank_mask:0xf
v_mul_f32_dpp v17, v76, v103 quad_perm:[1,0,3,2] row_mask:0xf bank_mask:0xf
v_fma_f32 v60, v60, v98, v16
v_fma_f32 v76, v76, v102, v17
v_mul_f32_dpp v16, v61, v99 quad_perm:[1,0,3,2] row_mask:0xf bank_mask:0xf
v_mul_f32_dpp v17, v77, v103 quad_perm:[1,0,3,2] row_mask:0xf bank_mask:0xf
v_fma_f32 v61, v61, v98, v16
v_fma_f32 v77, v77, v102, v17
v_mul_f32_dpp v16, v62, v99 quad_perm:[1,0,3,2] row_mask:0xf bank_mask:0xf
v_mul_f32_dpp v17, v78, v103 quad_perm:[1,0,3,2] row_mask:0xf bank_mask:0xf
v_fma_f32 v62, v62, v98, v16
v_fma_f32 v78, v78, v102, v17
v_mul_f32_dpp v16, v63, v99 quad_perm:[1,0,3,2] row_mask:0xf bank_mask:0xf
v_mul_f32_dpp v17, v79, v103 quad_perm:[1,0,3,2] row_mask:0xf bank_mask:0xf
v_fma_f32 v63, v63, v98, v16
v_fma_f32 v79, v79, v102, v17
v_fma_f32 v20, v48, v96, v49
v_fma_f32 v21, v64, v100, v65
s_nop 0
v_fmac_f32_dpp v20, v48, v97 quad_perm:[1,0,3,2] row_mask:0xf bank_mask:0xf
v_fmac_f32_dpp v21, v64, v101 quad_perm:[1,0,3,2] row_mask:0xf bank_mask:0xf
v_fma_f32 v24, v20, v96, v50
v_fma_f32 v25, v21, v100, v66
s_nop 0
v_fmac_f32_dpp v24, v20, v97 quad_perm:[1,0,3,2] row_mask:0xf bank_mask:0xf
v_fmac_f32_dpp v25, v21, v101 quad_perm:[1,0,3,2] row_mask:0xf bank_mask:0xf
v_fma_f32 v20, v24, v96, v51
v_fma_f32 v21, v25, v100, v67
s_nop 0
v_fmac_f32_dpp v20, v24, v97 quad_perm:[1,0,3,2] row_mask:0xf bank_mask:0xf
v_fmac_f32_dpp v21, v25, v101 quad_perm:[1,0,3,2] row_mask:0xf bank_mask:0xf
v_fma_f32 v24, v20, v96, v52
v_fma_f32 v25, v21, v100, v68
s_nop 0
v_fmac_f32_dpp v24, v20, v97 quad_perm:[1,0,3,2] row_mask:0xf bank_mask:0xf
v_fmac_f32_dpp v25, v21, v101 quad_perm:[1,0,3,2] row_mask:0xf bank_mask:0xf
v_fma_f32 v20, v24, v96, v53
v_fma_f32 v21, v25, v100, v69
s_nop 0
v_fmac_f32_dpp v20, v24, v97 quad_perm:[1,0,3,2] row_mask:0xf bank_mask:0xf
v_fmac_f32_dpp v21, v25, v101 quad_perm:[1,0,3,2] row_mask:0xf bank_mask:0xf
v_fma_f32 v24, v20, v96, v54
v_fma_f32 v25, v21, v100, v70
s_nop 0
v_fmac_f32_dpp v24, v20, v97 quad_perm:[1,0,3,2] row_mask:0xf bank_mask:0xf
v_fmac_f32_dpp v25, v21, v101 quad_perm:[1,0,3,2] row_mask:0xf bank_mask:0xf
v_fma_f32 v20, v24, v96, v55
v_fma_f32 v21, v25, v100, v71
s_nop 0
v_fmac_f32_dpp v20, v24, v97 quad_perm:[1,0,3,2] row_mask:0xf bank_mask:0xf
v_fmac_f32_dpp v21, v25, v101 quad_perm:[1,0,3,2] row_mask:0xf bank_mask:0xf
v_fma_f32 v24, v20, v96, v56
v_fma_f32 v25, v21, v100, v72
s_nop 0
v_fmac_f32_dpp v24, v20, v97 quad_perm:[1,0,3,2] row_mask:0xf bank_mask:0xf
v_fmac_f32_dpp v25, v21, v101 quad_perm:[1,0,3,2] row_mask:0xf bank_mask:0xf
v_fma_f32 v20, v24, v96, v57
v_fma_f32 v21, v25, v100, v73
s_nop 0
v_fmac_f32_dpp v20, v24, v97 quad_perm:[1,0,3,2] row_mask:0xf bank_mask:0xf
v_fmac_f32_dpp v21, v25, v101 quad_perm:[1,0,3,2] row_mask:0xf bank_mask:0xf
v_fma_f32 v24, v20, v96, v58
v_fma_f32 v25, v21, v100, v74
s_nop 0
v_fmac_f32_dpp v24, v20, v97 quad_perm:[1,0,3,2] row_mask:0xf bank_mask:0xf
v_fmac_f32_dpp v25, v21, v101 quad_perm:[1,0,3,2] row_mask:0xf bank_mask:0xf
v_fma_f32 v20, v24, v96, v59
v_fma_f32 v21, v25, v100, v75
s_nop 0
v_fmac_f32_dpp v20, v24, v97 quad_perm:[1,0,3,2] row_mask:0xf bank_mask:0xf
v_fmac_f32_dpp v21, v25, v101 quad_perm:[1,0,3,2] row_mask:0xf bank_mask:0xf
v_fma_f32 v24, v20, v96, v60
v_fma_f32 v25, v21, v100, v76
s_nop 0
v_fmac_f32_dpp v24, v20, v97 quad_perm:[1,0,3,2] row_mask:0xf bank_mask:0xf
v_fmac_f32_dpp v25, v21, v101 quad_perm:[1,0,3,2] row_mask:0xf bank_mask:0xf
v_fma_f32 v20, v24, v96, v61
v_fma_f32 v21, v25, v100, v77
s_nop 0
v_fmac_f32_dpp v20, v24, v97 quad_perm:[1,0,3,2] row_mask:0xf bank_mask:0xf
v_fmac_f32_dpp v21, v25, v101 quad_perm:[1,0,3,2] row_mask:0xf bank_mask:0xf
v_fma_f32 v24, v20, v96, v62
v_fma_f32 v25, v21, v100, v78
s_nop 0
v_fmac_f32_dpp v24, v20, v97 quad_perm:[1,0,3,2] row_mask:0xf bank_mask:0xf
v_fmac_f32_dpp v25, v21, v101 quad_perm:[1,0,3,2] row_mask:0xf bank_mask:0xf
v_fma_f32 v20, v24, v96, v63
v_fma_f32 v21, v25, v100, v79
s_nop 0
v_fmac_f32_dpp v20, v24, v97 quad_perm:[1,0,3,2] row_mask:0xf bank_mask:0xf
v_fmac_f32_dpp v21, v25, v101 quad_perm:[1,0,3,2] row_mask:0xf bank_mask:0xf
v_lshrrev_b32 v13, 5, v0
v_mul_u32_u24 v13, 640, v13
v_lshl_add_u32 v13, v11, 2, v13
s_mul_i32 s73, s7, 1280
s_add_u32 s73, s73, 148480
v_add_u32 v13, s73, v13
ds_write_b32 v13, v20 offset:0
ds_write_b32 v13, v21 offset:128
s_waitcnt lgkmcnt(0)
s_barrier
s_lshl_b32 s73, s3, 11
s_add_u32 s73, s73, 81920
v_and_b32 v12, 31, v0
v_bfe_u32 v14, v0, 2, 2
v_lshrrev_b32 v15, 5, v0
v_lshlrev_b32 v15, 1, v15
v_xor_b32 v14, v14, v15
v_lshlrev_b32 v12, 6, v12
v_lshl_add_u32 v8, v14, 4, v12
v_add_u32 v8, s73, v8
v_xor_b32 v9, 16, v8
v_bfe_u32 v12, v0, 2, 2
v_lshrrev_b32 v13, 5, v0
v_lshl_add_u32 v12, v13, 3, v12
v_lshlrev_b32 v12, 6, v12
v_bfe_u32 v14, v0, 4, 1
v_bfe_u32 v15, v0, 1, 1
v_lshl_add_u32 v14, v14, 1, v15
v_lshlrev_b32 v13, 1, v13
v_xor_b32 v14, v14, v13
v_and_b32 v15, 1, v0
v_lshl_add_u32 v12, v15, 3, v12
v_add_u32 v12, s73, v12
v_lshl_add_u32 v10, v14, 4, v12
v_xor_b32 v14, 1, v14
v_lshl_add_u32 v7, v14, 4, v12
v_add_u32 v7, 256, v7
v_lshrrev_b32 v13, 5, v0
v_mul_u32_u24 v13, 640, v13
v_lshl_add_u32 v13, v11, 2, v13
s_mul_i32 s73, s7, 1280
s_add_u32 s73, s73, 148480
v_add_u32 v13, s73, v13
s_barrier
ds_read_b32 v16, v13 offset:0
ds_read_b32 v17, v13 offset:128
s_waitcnt lgkmcnt(0)
v_fmac_f32 v48, v16, v96
v_fmac_f32 v64, v17, v100
s_nop 0
v_fmac_f32_dpp v48, v16, v97 quad_perm:[1,0,3,2] row_mask:0xf bank_mask:0xf
v_fmac_f32_dpp v64, v17, v101 quad_perm:[1,0,3,2] row_mask:0xf bank_mask:0xf
v_fmac_f32 v49, v48, v96
v_fmac_f32 v65, v64, v100
s_nop 0
v_fmac_f32_dpp v49, v48, v97 quad_perm:[1,0,3,2] row_mask:0xf bank_mask:0xf
v_fmac_f32_dpp v65, v64, v101 quad_perm:[1,0,3,2] row_mask:0xf bank_mask:0xf
v_fmac_f32 v50, v49, v96
v_fmac_f32 v66, v65, v100
s_nop 0
v_fmac_f32_dpp v50, v49, v97 quad_perm:[1,0,3,2] row_mask:0xf bank_mask:0xf
v_fmac_f32_dpp v66, v65, v101 quad_perm:[1,0,3,2] row_mask:0xf bank_mask:0xf
v_fmac_f32 v51, v50, v96
v_fmac_f32 v67, v66, v100
s_nop 0
v_fmac_f32_dpp v51, v50, v97 quad_perm:[1,0,3,2] row_mask:0xf bank_mask:0xf
v_fmac_f32_dpp v67, v66, v101 quad_perm:[1,0,3,2] row_mask:0xf bank_mask:0xf
v_fmac_f32 v52, v51, v96
v_fmac_f32 v68, v67, v100
s_nop 0
v_fmac_f32_dpp v52, v51, v97 quad_perm:[1,0,3,2] row_mask:0xf bank_mask:0xf
v_fmac_f32_dpp v68, v67, v101 quad_perm:[1,0,3,2] row_mask:0xf bank_mask:0xf
v_fmac_f32 v53, v52, v96
v_fmac_f32 v69, v68, v100
s_nop 0
v_fmac_f32_dpp v53, v52, v97 quad_perm:[1,0,3,2] row_mask:0xf bank_mask:0xf
v_fmac_f32_dpp v69, v68, v101 quad_perm:[1,0,3,2] row_mask:0xf bank_mask:0xf
v_fmac_f32 v54, v53, v96
v_fmac_f32 v70, v69, v100
s_nop 0
v_fmac_f32_dpp v54, v53, v97 quad_perm:[1,0,3,2] row_mask:0xf bank_mask:0xf
v_fmac_f32_dpp v70, v69, v101 quad_perm:[1,0,3,2] row_mask:0xf bank_mask:0xf
v_fmac_f32 v55, v54, v96
v_fmac_f32 v71, v70, v100
s_nop 0
v_fmac_f32_dpp v55, v54, v97 quad_perm:[1,0,3,2] row_mask:0xf bank_mask:0xf
v_fmac_f32_dpp v71, v70, v101 quad_perm:[1,0,3,2] row_mask:0xf bank_mask:0xf
v_fmac_f32 v56, v55, v96
v_fmac_f32 v72, v71, v100
s_nop 0
v_fmac_f32_dpp v56, v55, v97 quad_perm:[1,0,3,2] row_mask:0xf bank_mask:0xf
v_fmac_f32_dpp v72, v71, v101 quad_perm:[1,0,3,2] row_mask:0xf bank_mask:0xf
v_fmac_f32 v57, v56, v96
v_fmac_f32 v73, v72, v100
s_nop 0
v_fmac_f32_dpp v57, v56, v97 quad_perm:[1,0,3,2] row_mask:0xf bank_mask:0xf
v_fmac_f32_dpp v73, v72, v101 quad_perm:[1,0,3,2] row_mask:0xf bank_mask:0xf
v_fmac_f32 v58, v57, v96
v_fmac_f32 v74, v73, v100
s_nop 0
v_fmac_f32_dpp v58, v57, v97 quad_perm:[1,0,3,2] row_mask:0xf bank_mask:0xf
v_fmac_f32_dpp v74, v73, v101 quad_perm:[1,0,3,2] row_mask:0xf bank_mask:0xf
v_fmac_f32 v59, v58, v96
v_fmac_f32 v75, v74, v100
s_nop 0
v_fmac_f32_dpp v59, v58, v97 quad_perm:[1,0,3,2] row_mask:0xf bank_mask:0xf
v_fmac_f32_dpp v75, v74, v101 quad_perm:[1,0,3,2] row_mask:0xf bank_mask:0xf
v_fmac_f32 v60, v59, v96
v_fmac_f32 v76, v75, v100
s_nop 0
v_fmac_f32_dpp v60, v59, v97 quad_perm:[1,0,3,2] row_mask:0xf bank_mask:0xf
v_fmac_f32_dpp v76, v75, v101 quad_perm:[1,0,3,2] row_mask:0xf bank_mask:0xf
v_fmac_f32 v61, v60, v96
v_fmac_f32 v77, v76, v100
s_nop 0
v_fmac_f32_dpp v61, v60, v97 quad_perm:[1,0,3,2] row_mask:0xf bank_mask:0xf
v_fmac_f32_dpp v77, v76, v101 quad_perm:[1,0,3,2] row_mask:0xf bank_mask:0xf
v_fmac_f32 v62, v61, v96
v_fmac_f32 v78, v77, v100
s_nop 0
v_fmac_f32_dpp v62, v61, v97 quad_perm:[1,0,3,2] row_mask:0xf bank_mask:0xf
v_fmac_f32_dpp v78, v77, v101 quad_perm:[1,0,3,2] row_mask:0xf bank_mask:0xf
v_fmac_f32 v63, v62, v96
v_fmac_f32 v79, v78, v100
s_nop 0
v_fmac_f32_dpp v63, v62, v97 quad_perm:[1,0,3,2] row_mask:0xf bank_mask:0xf
v_fmac_f32_dpp v79, v78, v101 quad_perm:[1,0,3,2] row_mask:0xf bank_mask:0xf
v_cvt_pk_bf16_f32 v40, v48, v49
v_cvt_pk_bf16_f32 v41, v50, v51
v_cvt_pk_bf16_f32 v42, v52, v53
v_cvt_pk_bf16_f32 v43, v54, v55
v_cvt_pk_bf16_f32 v44, v56, v57
v_cvt_pk_bf16_f32 v45, v58, v59
v_cvt_pk_bf16_f32 v46, v60, v61
v_cvt_pk_bf16_f32 v47, v62, v63
ds_write_b128 v8, v[40:43]
ds_write_b128 v9, v[44:47]
ds_read_b64_tr_b16 v[16:17], v10 offset:0
ds_read_b64_tr_b16 v[18:19], v7 offset:0
ds_read_b64_tr_b16 v[20:21], v10 offset:1024
ds_read_b64_tr_b16 v[22:23], v7 offset:1024
v_cvt_pk_bf16_f32 v40, v64, v65
v_cvt_pk_bf16_f32 v41, v66, v67
v_cvt_pk_bf16_f32 v42, v68, v69
v_cvt_pk_bf16_f32 v43, v70, v71
v_cvt_pk_bf16_f32 v44, v72, v73
v_cvt_pk_bf16_f32 v45, v74, v75
v_cvt_pk_bf16_f32 v46, v76, v77
v_cvt_pk_bf16_f32 v47, v78, v79
ds_write_b128 v8, v[40:43]
ds_write_b128 v9, v[44:47]
ds_read_b64_tr_b16 v[24:25], v10 offset:0
ds_read_b64_tr_b16 v[26:27], v7 offset:0
ds_read_b64_tr_b16 v[28:29], v10 offset:1024
ds_read_b64_tr_b16 v[30:31], v7 offset:1024
s_waitcnt lgkmcnt(0)
s_lshl_b32 s76, s5, 3
s_add_u32 s76, s76, s6
s_lshl_b32 s76, s76, 2
s_add_u32 s76, s76, s7
s_lshl_b32 s76, s76, 1
s_add_u32 s76, s76, s8
s_mul_i32 s76, s76, 6144
s_add_u32 s76, s76, 3145728
v_lshlrev_b32 v1, 4, v0
s_cmp_eq_u32 s96, 1
s_cbranch_scc1 L_PUBL_6
buffer_store_dwordx4 v[16:19], v1, s[12:15], s76 offen offset:0 sc1
buffer_store_dwordx4 v[20:23], v1, s[12:15], s76 offen offset:1024 sc1
buffer_store_dwordx4 v[24:27], v1, s[12:15], s76 offen offset:2048 sc1
buffer_store_dwordx4 v[28:31], v1, s[12:15], s76 offen offset:3072 sc1
s_branch L_PUBD_7
L_PUBL_6:
buffer_store_dwordx4 v[16:19], v1, s[12:15], s76 offen offset:0 sc1
buffer_store_dwordx4 v[20:23], v1, s[12:15], s76 offen offset:1024 sc1
buffer_store_dwordx4 v[24:27], v1, s[12:15], s76 offen offset:2048 sc1
buffer_store_dwordx4 v[28:31], v1, s[12:15], s76 offen offset:3072 sc1
L_PUBD_7:
v_lshlrev_b32 v4, 4, v0
v_add_u32 v4, 15360, v4
v_lshlrev_b32 v1, 4, v0
v_add_u32 v8, 122880, v4
v_add_u32 v9, 0, v4
s_barrier
ds_read_b128 v[64:67], v8 offset:0
ds_read_b128 v[68:71], v8 offset:1024
ds_read_b128 v[72:75], v8 offset:2048
ds_read_b128 v[76:79], v8 offset:3072
ds_read_b128 v[80:83], v8 offset:4096
s_waitcnt lgkmcnt(4)
v_mfma_f32_32x32x16_bf16 v[88:103], v[64:67], v[16:19], 0
ds_read_b128 v[84:87], v8 offset:5120
s_waitcnt lgkmcnt(4)
v_mfma_f32_32x32x16_bf16 v[104:119], v[68:71], v[16:19], 0
ds_read_b128 v[64:67], v8 offset:6144
s_waitcnt lgkmcnt(4)
v_mfma_f32_32x32x16_bf16 v[120:135], v[72:75], v[16:19], 0
ds_read_b128 v[68:71], v8 offset:7168
s_waitcnt lgkmcnt(4)
v_mfma_f32_32x32x16_bf16 v[136:151], v[76:79], v[16:19], 0
ds_read_b128 v[72:75], v8 offset:8192
s_waitcnt lgkmcnt(4)
v_mfma_f32_32x32x16_bf16 v[152:167], v[80:83], v[16:19], 0
ds_read_b128 v[76:79], v8 offset:9216
s_lshl_b32 s77, s5, 1
s_add_u32 s77, s77, s9
s_lshl_b32 s77, s77, 2
s_add_u32 s77, s77, s7
s_lshl_b32 s77, s77, 1
s_add_u32 s77, s77, s8
s_lshl_b32 s77, s77, 7
s_add_u32 s77, s77, 294912
s_lshl_b32 s76, s10, 2
s_add_u32 s76, s76, s77
s_waitcnt vmcnt(0)
v_mov_b32 v2, s11
s_mov_b64 exec, 1
s_cmp_eq_u32 s96, 1
s_cbranch_scc1 L_FLGL_8
buffer_store_dword v2, off, s[12:15], s76 sc1
s_branch L_FLGD_9
L_FLGL_8:
buffer_store_dword v2, off, s[12:15], s76
L_FLGD_9:
s_mov_b64 exec, -1
s_waitcnt lgkmcnt(4)
v_mfma_f32_32x32x16_bf16 v[88:103], v[84:87], v[20:23], v[88:103]
s_waitcnt lgkmcnt(3)
v_mfma_f32_32x32x16_bf16 v[104:119], v[64:67], v[20:23], v[104:119]
s_waitcnt lgkmcnt(0)
s_barrier
v_add_u32 v8, 25600, v4
ds_read_b128 v[80:83], v9 offset:0
ds_read_b128 v[84:87], v9 offset:1024
v_mfma_f32_32x32x16_bf16 v[120:135], v[68:71], v[20:23], v[120:135]
ds_read_b128 v[64:67], v9 offset:2048
v_mfma_f32_32x32x16_bf16 v[136:151], v[72:75], v[20:23], v[136:151]
ds_read_b128 v[68:71], v9 offset:3072
v_mfma_f32_32x32x16_bf16 v[152:167], v[76:79], v[20:23], v[152:167]
ds_read_b128 v[72:75], v9 offset:4096
s_lshl_b32 s79, s5, 1
s_add_u32 s79, s79, s9
s_lshl_b32 s79, s79, 2
s_add_u32 s79, s79, s7
s_lshl_b32 s79, s79, 1
s_add_u32 s79, s79, s8
s_lshl_b32 s79, s79, 7
s_add_u32 s79, s79, 294912
buffer_load_dwordx4 v[12:15], off, s[12:15], s79 sc1
s_add_u32 s73, s10, 1
s_and_b32 s73, s73, 3
s_lshl_b32 s74, s9, 2
s_add_u32 s73, s73, s74
s_lshl_b32 s84, s5, 3
s_add_u32 s84, s84, s73
s_lshl_b32 s84, s84, 2
s_add_u32 s84, s84, s7
s_lshl_b32 s84, s84, 1
s_add_u32 s84, s84, s8
s_mul_i32 s84, s84, 6144
s_add_u32 s84, s84, 3145728
s_add_u32 s87, s84, 4096
s_add_u32 s73, s10, 2
s_and_b32 s73, s73, 3
s_lshl_b32 s74, s9, 2
s_add_u32 s73, s73, s74
s_lshl_b32 s85, s5, 3
s_add_u32 s85, s85, s73
s_lshl_b32 s85, s85, 2
s_add_u32 s85, s85, s7
s_lshl_b32 s85, s85, 1
s_add_u32 s85, s85, s8
s_mul_i32 s85, s85, 6144
s_add_u32 s85, s85, 3145728
s_add_u32 s88, s85, 4096
s_add_u32 s73, s10, 3
s_and_b32 s73, s73, 3
s_lshl_b32 s74, s9, 2
s_add_u32 s73, s73, s74
s_lshl_b32 s86, s5, 3
s_add_u32 s86, s86, s73
s_lshl_b32 s86, s86, 2
s_add_u32 s86, s86, s7
s_lshl_b32 s86, s86, 1
s_add_u32 s86, s86, s8
s_mul_i32 s86, s86, 6144
s_add_u32 s86, s86, 3145728
s_add_u32 s89, s86, 4096
s_waitcnt lgkmcnt(4)
v_mfma_f32_32x32x16_bf16 v[88:103], v[80:83], v[24:27], v[88:103]
ds_read_b128 v[76:79], v9 offset:5120
s_add_u32 s81, s9, 0
s_lshl_b32 s82, s5, 7
s_lshl_b32 s83, s81, 5
s_add_u32 s82, s82, s83
v_and_b32 v2, 31, v0
v_add_u32 v2, s82, v2
v_lshrrev_b32 v3, 5, v0
v_lshlrev_b32 v3, 3, v3
v_mul_u32_u24 v6, 1280, v2
v_add_u32 v6, v6, v3
s_add_u32 s82, s3, 0
s_min_u32 s82, s82, 9
s_lshr_b32 s83, s82, 1
s_lshl_b32 s83, s83, 6
s_and_b32 s82, s82, 1
s_lshl_b32 s82, s82, 5
s_add_u32 s90, s82, s83
s_add_u32 s82, s3, 8
s_min_u32 s82, s82, 9
s_lshr_b32 s83, s82, 1
s_lshl_b32 s83, s83, 6
s_and_b32 s82, s82, 1
s_lshl_b32 s82, s82, 5
s_add_u32 s91, s82, s83
s_mul_i32 s92, s10, 320
s_waitcnt lgkmcnt(4)
v_mfma_f32_32x32x16_bf16 v[104:119], v[84:87], v[24:27], v[104:119]
ds_read_b128 v[80:83], v9 offset:6144
s_waitcnt lgkmcnt(4)
v_mfma_f32_32x32x16_bf16 v[120:135], v[64:67], v[24:27], v[120:135]
ds_read_b128 v[84:87], v9 offset:7168
s_waitcnt lgkmcnt(4)
v_mfma_f32_32x32x16_bf16 v[136:151], v[68:71], v[24:27], v[136:151]
ds_read_b128 v[64:67], v9 offset:8192
s_waitcnt lgkmcnt(4)
v_mfma_f32_32x32x16_bf16 v[152:167], v[72:75], v[24:27], v[152:167]
ds_read_b128 v[68:71], v9 offset:9216
s_waitcnt vmcnt(0)
s_mov_b32 s80, 65536
L_PF1_S1:
v_xor_b32 v12, s11, v12
v_xor_b32 v13, s11, v13
v_xor_b32 v14, s11, v14
v_xor_b32 v15, s11, v15
v_or3_b32 v12, v12, v13, v14
v_or_b32 v12, v12, v15
v_cmp_ne_u32 vcc, 0, v12
s_cbranch_vccz L_PF1_S1_ok
s_sub_u32 s80, s80, 1
s_cmp_eq_u32 s80, 0
s_cbranch_scc1 L_PF1_S1_ok
buffer_load_dwordx4 v[12:15], off, s[12:15], s79 sc1
s_waitcnt vmcnt(0)
s_branch L_PF1_S1
L_PF1_S1_ok:
buffer_load_dwordx4 v[40:43], v1, s[12:15], s84 offen offset:0
s_waitcnt lgkmcnt(4)
v_mfma_f32_32x32x16_bf16 v[88:103], v[76:79], v[28:31], v[88:103]
s_waitcnt lgkmcnt(3)
v_mfma_f32_32x32x16_bf16 v[104:119], v[80:83], v[28:31], v[104:119]
s_waitcnt lgkmcnt(0)
s_barrier
v_add_u32 v9, 51200, v4
ds_read_b128 v[72:75], v8 offset:0
ds_read_b128 v[76:79], v8 offset:1024
v_mfma_f32_32x32x16_bf16 v[120:135], v[84:87], v[28:31], v[120:135]
ds_read_b128 v[80:83], v8 offset:2048
buffer_load_dwordx4 v[44:47], v1, s[12:15], s84 offen offset:1024
v_mfma_f32_32x32x16_bf16 v[136:151], v[64:67], v[28:31], v[136:151]
ds_read_b128 v[84:87], v8 offset:3072
v_mfma_f32_32x32x16_bf16 v[152:167], v[68:71], v[28:31], v[152:167]
ds_read_b128 v[64:67], v8 offset:4096
s_waitcnt vmcnt(1)
s_waitcnt lgkmcnt(4)
v_mfma_f32_32x32x16_bf16 v[88:103], v[72:75], v[40:43], v[88:103]
ds_read_b128 v[68:71], v8 offset:5120
buffer_load_dwordx4 v[48:51], v1, s[12:15], s84 offen offset:2048
s_waitcnt lgkmcnt(4)
v_mfma_f32_32x32x16_bf16 v[104:119], v[76:79], v[40:43], v[104:119]
ds_read_b128 v[72:75], v8 offset:6144
s_waitcnt lgkmcnt(4)
v_mfma_f32_32x32x16_bf16 v[120:135], v[80:83], v[40:43], v[120:135]
ds_read_b128 v[76:79], v8 offset:7168
s_waitcnt lgkmcnt(4)
v_mfma_f32_32x32x16_bf16 v[136:151], v[84:87], v[40:43], v[136:151]
ds_read_b128 v[80:83], v8 offset:8192
buffer_load_dwordx4 v[52:55], v1, s[12:15], s84 offen offset:3072
s_waitcnt lgkmcnt(4)
v_mfma_f32_32x32x16_bf16 v[152:167], v[64:67], v[40:43], v[152:167]
ds_read_b128 v[84:87], v8 offset:9216
s_waitcnt vmcnt(2)
s_waitcnt lgkmcnt(4)
v_mfma_f32_32x32x16_bf16 v[88:103], v[68:71], v[44:47], v[88:103]
s_waitcnt lgkmcnt(3)
v_mfma_f32_32x32x16_bf16 v[104:119], v[72:75], v[44:47], v[104:119]
buffer_load_dwordx4 v[16:19], v1, s[12:15], s85 offen offset:0
s_waitcnt lgkmcnt(0)
s_barrier
v_add_u32 v8, 76800, v4
ds_read_b128 v[64:67], v9 offset:0
ds_read_b128 v[68:71], v9 offset:1024
v_mfma_f32_32x32x16_bf16 v[120:135], v[76:79], v[44:47], v[120:135]
ds_read_b128 v[72:75], v9 offset:2048
v_mfma_f32_32x32x16_bf16 v[136:151], v[80:83], v[44:47], v[136:151]
ds_read_b128 v[76:79], v9 offset:3072
v_mfma_f32_32x32x16_bf16 v[152:167], v[84:87], v[44:47], v[152:167]
ds_read_b128 v[80:83], v9 offset:4096
buffer_load_dwordx4 v[20:23], v1, s[12:15], s85 offen offset:1024
s_waitcnt vmcnt(3)
s_waitcnt lgkmcnt(4)
v_mfma_f32_32x32x16_bf16 v[88:103], v[64:67], v[48:51], v[88:103]
ds_read_b128 v[84:87], v9 offset:5120
s_waitcnt lgkmcnt(4)
v_mfma_f32_32x32x16_bf16 v[104:119], v[68:71], v[48:51], v[104:119]
ds_read_b128 v[64:67], v9 offset:6144
s_waitcnt lgkmcnt(4)
v_mfma_f32_32x32x16_bf16 v[120:135], v[72:75], v[48:51], v[120:135]
ds_read_b128 v[68:71], v9 offset:7168
buffer_load_dwordx4 v[24:27], v1, s[12:15], s85 offen offset:2048
s_waitcnt lgkmcnt(4)
v_mfma_f32_32x32x16_bf16 v[136:151], v[76:79], v[48:51], v[136:151]
ds_read_b128 v[72:75], v9 offset:8192
s_waitcnt lgkmcnt(4)
v_mfma_f32_32x32x16_bf16 v[152:167], v[80:83], v[48:51], v[152:167]
ds_read_b128 v[76:79], v9 offset:9216
s_waitcnt vmcnt(3)
s_waitcnt lgkmcnt(4)
v_mfma_f32_32x32x16_bf16 v[88:103], v[84:87], v[52:55], v[88:103]
buffer_load_dwordx4 v[28:31], v1, s[12:15], s85 offen offset:3072
s_waitcnt lgkmcnt(3)
v_mfma_f32_32x32x16_bf16 v[104:119], v[64:67], v[52:55], v[104:119]
s_waitcnt lgkmcnt(0)
s_barrier
v_add_u32 v9, 122880, v4
ds_read_b128 v[80:83], v8 offset:0
ds_read_b128 v[84:87], v8 offset:1024
v_mfma_f32_32x32x16_bf16 v[120:135], v[68:71], v[52:55], v[120:135]
ds_read_b128 v[64:67], v8 offset:2048
v_mfma_f32_32x32x16_bf16 v[136:151], v[72:75], v[52:55], v[136:151]
ds_read_b128 v[68:71], v8 offset:3072
buffer_load_dwordx4 v[40:43], v1, s[12:15], s86 offen offset:0
v_mfma_f32_32x32x16_bf16 v[152:167], v[76:79], v[52:55], v[152:167]
ds_read_b128 v[72:75], v8 offset:4096
s_waitcnt vmcnt(4)
s_waitcnt lgkmcnt(4)
v_mfma_f32_32x32x16_bf16 v[88:103], v[80:83], v[16:19], v[88:103]
ds_read_b128 v[76:79], v8 offset:5120
s_waitcnt lgkmcnt(4)
v_mfma_f32_32x32x16_bf16 v[104:119], v[84:87], v[16:19], v[104:119]
ds_read_b128 v[80:83], v8 offset:6144
buffer_load_dwordx4 v[44:47], v1, s[12:15], s86 offen offset:1024
s_waitcnt lgkmcnt(4)
v_mfma_f32_32x32x16_bf16 v[120:135], v[64:67], v[16:19], v[120:135]
ds_read_b128 v[84:87], v8 offset:7168
s_waitcnt lgkmcnt(4)
v_mfma_f32_32x32x16_bf16 v[136:151], v[68:71], v[16:19], v[136:151]
ds_read_b128 v[64:67], v8 offset:8192
s_waitcnt lgkmcnt(4)
v_mfma_f32_32x32x16_bf16 v[152:167], v[72:75], v[16:19], v[152:167]
ds_read_b128 v[68:71], v8 offset:9216
buffer_load_dwordx4 v[48:51], v1, s[12:15], s86 offen offset:2048
s_waitcnt vmcnt(5)
s_waitcnt lgkmcnt(4)
v_mfma_f32_32x32x16_bf16 v[88:103], v[76:79], v[20:23], v[88:103]
s_waitcnt lgkmcnt(3)
v_mfma_f32_32x32x16_bf16 v[104:119], v[80:83], v[20:23], v[104:119]
s_waitcnt lgkmcnt(0)
s_barrier
v_add_u32 v8, 0, v4
ds_read_b128 v[72:75], v9 offset:0
ds_read_b128 v[76:79], v9 offset:1024
v_mfma_f32_32x32x16_bf16 v[120:135], v[84:87], v[20:23], v[120:135]
ds_read_b128 v[80:83], v9 offset:2048
buffer_load_dwordx4 v[52:55], v1, s[12:15], s86 offen offset:3072
v_mfma_f32_32x32x16_bf16 v[136:151], v[64:67], v[20:23], v[136:151]
ds_read_b128 v[84:87], v9 offset:3072
v_mfma_f32_32x32x16_bf16 v[152:167], v[68:71], v[20:23], v[152:167]
ds_read_b128 v[64:67], v9 offset:4096
s_waitcnt vmcnt(5)
s_waitcnt lgkmcnt(4)
v_mfma_f32_32x32x16_bf16 v[88:103], v[72:75], v[24:27], v[88:103]
ds_read_b128 v[68:71], v9 offset:5120
s_waitcnt lgkmcnt(4)
v_mfma_f32_32x32x16_bf16 v[104:119], v[76:79], v[24:27], v[104:119]
ds_read_b128 v[72:75], v9 offset:6144
s_waitcnt lgkmcnt(4)
v_mfma_f32_32x32x16_bf16 v[120:135], v[80:83], v[24:27], v[120:135]
ds_read_b128 v[76:79], v9 offset:7168
s_waitcnt lgkmcnt(4)
v_mfma_f32_32x32x16_bf16 v[136:151], v[84:87], v[24:27], v[136:151]
ds_read_b128 v[80:83], v9 offset:8192
s_waitcnt lgkmcnt(4)
v_mfma_f32_32x32x16_bf16 v[152:167], v[64:67], v[24:27], v[152:167]
ds_read_b128 v[84:87], v9 offset:9216
s_waitcnt vmcnt(4)
s_waitcnt lgkmcnt(4)
v_mfma_f32_32x32x16_bf16 v[88:103], v[68:71], v[28:31], v[88:103]
s_waitcnt lgkmcnt(3)
v_mfma_f32_32x32x16_bf16 v[104:119], v[72:75], v[28:31], v[104:119]
s_waitcnt lgkmcnt(0)
s_barrier
v_add_u32 v9, 25600, v4
ds_read_b128 v[64:67], v8 offset:0
ds_read_b128 v[68:71], v8 offset:1024
v_mfma_f32_32x32x16_bf16 v[120:135], v[76:79], v[28:31], v[120:135]
ds_read_b128 v[72:75], v8 offset:2048
v_mfma_f32_32x32x16_bf16 v[136:151], v[80:83], v[28:31], v[136:151]
ds_read_b128 v[76:79], v8 offset:3072
v_mfma_f32_32x32x16_bf16 v[152:167], v[84:87], v[28:31], v[152:167]
ds_read_b128 v[80:83], v8 offset:4096
s_add_u32 s82, s92, s90
buffer_load_dwordx2 v[16:17], v6, s[16:19], s82 offen offset:0
buffer_load_dwordx2 v[18:19], v6, s[16:19], s82 offen offset:16
s_cmp_ge_u32 s3, 2
s_cbranch_scc1 L_FXL_S1
s_add_u32 s82, s92, s91
buffer_load_dwordx2 v[20:21], v6, s[16:19], s82 offen offset:0
buffer_load_dwordx2 v[22:23], v6, s[16:19], s82 offen offset:16
L_FXL_S1:
s_waitcnt vmcnt(3)
s_waitcnt lgkmcnt(4)
v_mfma_f32_32x32x16_bf16 v[88:103], v[64:67], v[40:43], v[88:103]
ds_read_b128 v[84:87], v8 offset:5120
s_waitcnt lgkmcnt(4)
v_mfma_f32_32x32x16_bf16 v[104:119], v[68:71], v[40:43], v[104:119]
ds_read_b128 v[64:67], v8 offset:6144
s_waitcnt lgkmcnt(4)
v_mfma_f32_32x32x16_bf16 v[120:135], v[72:75], v[40:43], v[120:135]
ds_read_b128 v[68:71], v8 offset:7168
s_waitcnt lgkmcnt(4)
v_mfma_f32_32x32x16_bf16 v[136:151], v[76:79], v[40:43], v[136:151]
ds_read_b128 v[72:75], v8 offset:8192
s_waitcnt lgkmcnt(4)
v_mfma_f32_32x32x16_bf16 v[152:167], v[80:83], v[40:43], v[152:167]
ds_read_b128 v[76:79], v8 offset:9216
s_waitcnt vmcnt(2)
s_waitcnt lgkmcnt(4)
v_mfma_f32_32x32x16_bf16 v[88:103], v[84:87], v[44:47], v[88:103]
s_waitcnt lgkmcnt(3)
v_mfma_f32_32x32x16_bf16 v[104:119], v[64:67], v[44:47], v[104:119]
s_waitcnt lgkmcnt(0)
s_barrier
ds_read_b128 v[80:83], v9 offset:0
ds_read_b128 v[84:87], v9 offset:1024
v_mfma_f32_32x32x16_bf16 v[120:135], v[68:71], v[44:47], v[120:135]
ds_read_b128 v[64:67], v9 offset:2048
v_mfma_f32_32x32x16_bf16 v[136:151], v[72:75], v[44:47], v[136:151]
ds_read_b128 v[68:71], v9 offset:3072
v_mfma_f32_32x32x16_bf16 v[152:167], v[76:79], v[44:47], v[152:167]
ds_read_b128 v[72:75], v9 offset:4096
s_waitcnt vmcnt(1)
s_waitcnt lgkmcnt(4)
v_mfma_f32_32x32x16_bf16 v[88:103], v[80:83], v[48:51], v[88:103]
ds_read_b128 v[76:79], v9 offset:5120
s_waitcnt lgkmcnt(4)
v_mfma_f32_32x32x16_bf16 v[104:119], v[84:87], v[48:51], v[104:119]
ds_read_b128 v[80:83], v9 offset:6144
s_waitcnt lgkmcnt(4)
v_mfma_f32_32x32x16_bf16 v[120:135], v[64:67], v[48:51], v[120:135]
ds_read_b128 v[84:87], v9 offset:7168
s_waitcnt lgkmcnt(4)
v_mfma_f32_32x32x16_bf16 v[136:151], v[68:71], v[48:51], v[136:151]
ds_read_b128 v[64:67], v9 offset:8192
s_waitcnt lgkmcnt(4)
v_mfma_f32_32x32x16_bf16 v[152:167], v[72:75], v[48:51], v[152:167]
ds_read_b128 v[68:71], v9 offset:9216
s_waitcnt vmcnt(0)
s_waitcnt lgkmcnt(4)
v_mfma_f32_32x32x16_bf16 v[88:103], v[76:79], v[52:55], v[88:103]
s_waitcnt lgkmcnt(3)
v_mfma_f32_32x32x16_bf16 v[104:119], v[80:83], v[52:55], v[104:119]
s_waitcnt lgkmcnt(0)
s_barrier
v_mfma_f32_32x32x16_bf16 v[120:135], v[84:87], v[52:55], v[120:135]
v_mfma_f32_32x32x16_bf16 v[136:151], v[64:67], v[52:55], v[136:151]
v_mfma_f32_32x32x16_bf16 v[152:167], v[68:71], v[52:55], v[152:167]
L_FIN_S:
s_mul_i32 s73, s3, 10240
v_add_u32 v4, s73, v1
s_xor_b32 s73, s3, 4
s_mul_i32 s73, s73, 10240
v_add_u32 v5, s73, v1
s_cmp_eq_u32 s8, 0
s_cbranch_scc1 L_FX0_S
ds_write_b128 v4, v[88:91] offset:0
ds_write_b128 v4, v[92:95] offset:1024
ds_write_b128 v4, v[96:99] offset:2048
ds_write_b128 v4, v[100:103] offset:3072
ds_write_b128 v4, v[104:107] offset:4096
ds_write_b128 v4, v[108:111] offset:5120
ds_write_b128 v4, v[112:115] offset:6144
ds_write_b128 v4, v[116:119] offset:7168
ds_write_b128 v4, v[120:123] offset:8192
ds_write_b128 v4, v[124:127] offset:9216
s_waitcnt lgkmcnt(0)
s_barrier
ds_read_b128 v[88:91], v5 offset:0
ds_read_b128 v[92:95], v5 offset:1024
ds_read_b128 v[96:99], v5 offset:2048
ds_read_b128 v[100:103], v5 offset:3072
ds_read_b128 v[104:107], v5 offset:4096
ds_read_b128 v[108:111], v5 offset:5120
ds_read_b128 v[112:115], v5 offset:6144
ds_read_b128 v[116:119], v5 offset:7168
ds_read_b128 v[120:123], v5 offset:8192
ds_read_b128 v[124:127], v5 offset:9216
s_waitcnt lgkmcnt(0)
v_pk_add_f32 v[88:89], v[88:89], v[128:129]
v_pk_add_f32 v[90:91], v[90:91], v[130:131]
v_pk_add_f32 v[92:93], v[92:93], v[132:133]
v_pk_add_f32 v[94:95], v[94:95], v[134:135]
v_pk_add_f32 v[96:97], v[96:97], v[136:137]
v_pk_add_f32 v[98:99], v[98:99], v[138:139]
v_pk_add_f32 v[100:101], v[100:101], v[140:141]
v_pk_add_f32 v[102:103], v[102:103], v[142:143]
v_pk_add_f32 v[104:105], v[104:105], v[144:145]
v_pk_add_f32 v[106:107], v[106:107], v[146:147]
v_pk_add_f32 v[108:109], v[108:109], v[148:149]
v_pk_add_f32 v[110:111], v[110:111], v[150:151]
v_pk_add_f32 v[112:113], v[112:113], v[152:153]
v_pk_add_f32 v[114:115], v[114:115], v[154:155]
v_pk_add_f32 v[116:117], v[116:117], v[156:157]
v_pk_add_f32 v[118:119], v[118:119], v[158:159]
v_pk_add_f32 v[120:121], v[120:121], v[160:161]
v_pk_add_f32 v[122:123], v[122:123], v[162:163]
v_pk_add_f32 v[124:125], v[124:125], v[164:165]
v_pk_add_f32 v[126:127], v[126:127], v[166:167]
s_branch L_FX1_S
L_FX0_S:
s_nop 2
ds_write_b128 v4, v[128:131] offset:0
ds_write_b128 v4, v[132:135] offset:1024
ds_write_b128 v4, v[136:139] offset:2048
ds_write_b128 v4, v[140:143] offset:3072
ds_write_b128 v4, v[144:147] offset:4096
ds_write_b128 v4, v[148:151] offset:5120
ds_write_b128 v4, v[152:155] offset:6144
ds_write_b128 v4, v[156:159] offset:7168
ds_write_b128 v4, v[160:163] offset:8192
ds_write_b128 v4, v[164:167] offset:9216
s_waitcnt lgkmcnt(0)
s_barrier
ds_read_b128 v[128:131], v5 offset:0
ds_read_b128 v[132:135], v5 offset:1024
ds_read_b128 v[136:139], v5 offset:2048
ds_read_b128 v[140:143], v5 offset:3072
ds_read_b128 v[144:147], v5 offset:4096
ds_read_b128 v[148:151], v5 offset:5120
ds_read_b128 v[152:155], v5 offset:6144
ds_read_b128 v[156:159], v5 offset:7168
ds_read_b128 v[160:163], v5 offset:8192
ds_read_b128 v[164:167], v5 offset:9216
s_waitcnt lgkmcnt(0)
v_pk_add_f32 v[88:89], v[88:89], v[128:129]
v_pk_add_f32 v[90:91], v[90:91], v[130:131]
v_pk_add_f32 v[92:93], v[92:93], v[132:133]
v_pk_add_f32 v[94:95], v[94:95], v[134:135]
v_pk_add_f32 v[96:97], v[96:97], v[136:137]
v_pk_add_f32 v[98:99], v[98:99], v[138:139]
v_pk_add_f32 v[100:101], v[100:101], v[140:141]
v_pk_add_f32 v[102:103], v[102:103], v[142:143]
v_pk_add_f32 v[104:105], v[104:105], v[144:145]
v_pk_add_f32 v[106:107], v[106:107], v[146:147]
v_pk_add_f32 v[108:109], v[108:109], v[148:149]
v_pk_add_f32 v[110:111], v[110:111], v[150:151]
v_pk_add_f32 v[112:113], v[112:113], v[152:153]
v_pk_add_f32 v[114:115], v[114:115], v[154:155]
v_pk_add_f32 v[116:117], v[116:117], v[156:157]
v_pk_add_f32 v[118:119], v[118:119], v[158:159]
v_pk_add_f32 v[120:121], v[120:121], v[160:161]
v_pk_add_f32 v[122:123], v[122:123], v[162:163]
v_pk_add_f32 v[124:125], v[124:125], v[164:165]
v_pk_add_f32 v[126:127], v[126:127], v[166:167]
L_FX1_S:
s_cmp_eq_u32 s7, s81
s_cbranch_scc1 L_OWN_S
s_lshl_b32 s84, s5, 2
s_add_u32 s84, s84, s10
s_lshl_b32 s84, s84, 2
s_add_u32 s84, s84, s7
s_lshl_b32 s82, s84, 8
s_add_u32 s82, s82, 589824
s_lshl_b32 s84, s84, 2
s_add_u32 s84, s84, s81
s_mul_i32 s84, s84, 10
s_mul_i32 s85, s8, 5
s_add_u32 s84, s84, s85
s_lshl_b32 s84, s84, 10
s_add_u32 s84, s84, 16777216
v_cvt_pk_bf16_f32 v128, v88, v89
v_cvt_pk_bf16_f32 v129, v90, v91
v_cvt_pk_bf16_f32 v130, v92, v93
v_cvt_pk_bf16_f32 v131, v94, v95
v_cvt_pk_bf16_f32 v132, v96, v97
v_cvt_pk_bf16_f32 v133, v98, v99
v_cvt_pk_bf16_f32 v134, v100, v101
v_cvt_pk_bf16_f32 v135, v102, v103
v_cvt_pk_bf16_f32 v136, v104, v105
v_cvt_pk_bf16_f32 v137, v106, v107
v_cvt_pk_bf16_f32 v138, v108, v109
v_cvt_pk_bf16_f32 v139, v110, v111
v_cvt_pk_bf16_f32 v140, v112, v113
v_cvt_pk_bf16_f32 v141, v114, v115
v_cvt_pk_bf16_f32 v142, v116, v117
v_cvt_pk_bf16_f32 v143, v118, v119
v_cvt_pk_bf16_f32 v144, v120, v121
v_cvt_pk_bf16_f32 v145, v122, v123
v_cvt_pk_bf16_f32 v146, v124, v125
v_cvt_pk_bf16_f32 v147, v126, v127
s_lshr_b32 s83, s7, 1
s_cmp_eq_u32 s83, 0
s_cselect_b32 s83, s96, 0
s_lshr_b32 s85, s7, 1
s_cmp_eq_u32 s85, 0
s_cbranch_scc1 L_FA_S
s_lshl_b32 s85, s9, 3
s_add_u32 s82, s82, s85
s_add_u32 s82, s82, 128
L_FA_S:
s_lshl_b32 s85, s8, 2
s_add_u32 s82, s82, s85
s_cmp_eq_u32 s83, 1
s_cbranch_scc1 L_SNDL_S
buffer_store_dwordx4 v[128:131], v1, s[12:15], s84 offen offset:0 sc1
buffer_store_dwordx4 v[132:135], v1, s[12:15], s84 offen offset:1024 sc1
buffer_store_dwordx4 v[136:139], v1, s[12:15], s84 offen offset:2048 sc1
buffer_store_dwordx4 v[140:143], v1, s[12:15], s84 offen offset:3072 sc1
s_add_u32 s84, s84, 4096
buffer_store_dwordx4 v[144:147], v1, s[12:15], s84 offen offset:0 sc1
s_branch L_SENT_S
L_SNDL_S:
buffer_store_dwordx4 v[128:131], v1, s[12:15], s84 offen offset:0 sc1
buffer_store_dwordx4 v[132:135], v1, s[12:15], s84 offen offset:1024 sc1
buffer_store_dwordx4 v[136:139], v1, s[12:15], s84 offen offset:2048 sc1
buffer_store_dwordx4 v[140:143], v1, s[12:15], s84 offen offset:3072 sc1
s_add_u32 s84, s84, 4096
buffer_store_dwordx4 v[144:147], v1, s[12:15], s84 offen offset:0 sc1
s_branch L_SENT_S
L_OWN_S:
s_mul_i32 s84, s8, 10240
s_add_u32 s84, s84, 81920
v_add_u32 v4, s84, v1
ds_write_b128 v4, v[88:91] offset:0
ds_write_b128 v4, v[92:95] offset:1024
ds_write_b128 v4, v[96:99] offset:2048
ds_write_b128 v4, v[100:103] offset:3072
ds_write_b128 v4, v[104:107] offset:4096
ds_write_b128 v4, v[108:111] offset:5120
ds_write_b128 v4, v[112:115] offset:6144
ds_write_b128 v4, v[116:119] offset:7168
ds_write_b128 v4, v[120:123] offset:8192
ds_write_b128 v4, v[124:127] offset:9216
L_SENT_S:
s_waitcnt lgkmcnt(0)
s_barrier
s_cmp_eq_u32 s7, s81
s_cbranch_scc1 L_NOFLAG_S
s_waitcnt vmcnt(0)
v_mov_b32 v12, s11
s_mov_b64 exec, 1
s_cmp_eq_u32 s83, 1
s_cbranch_scc1 L_FLL_S
buffer_store_dword v12, off, s[12:15], s82 sc1
s_branch L_FLD_S
L_FLL_S:
buffer_store_dword v12, off, s[12:15], s82
L_FLD_S:
s_mov_b64 exec, -1
L_NOFLAG_S:
s_lshl_b32 s84, s5, 2
s_add_u32 s84, s84, s10
s_lshl_b32 s84, s84, 2
s_add_u32 s84, s84, s81
s_lshl_b32 s82, s84, 8
s_add_u32 s82, s82, 589824
s_mul_i32 s84, s84, 40960
s_add_u32 s84, s84, 16777216
s_lshl_b32 s83, s3, 10
s_add_u32 s84, s84, s83
s_xor_b32 s85, s81, 1
s_mul_i32 s85, s85, 10240
s_add_u32 s85, s85, s84
s_add_u32 s86, s84, 20480
s_lshl_b32 s83, s3, 11
s_add_u32 s83, s83, 81920
v_add_u32 v5, s83, v1
v_add_u32 v4, 162560, v3
v_add_u32 v7, s90, v4
ds_read_b128 v[128:131], v5 offset:0
ds_read_b64 v[112:113], v7 offset:0
ds_read_b64 v[114:115], v7 offset:320
ds_read_b128 v[132:135], v5 offset:1024
ds_read_b64 v[116:117], v7 offset:16
ds_read_b64 v[118:119], v7 offset:336
s_cmp_ge_u32 s3, 2
s_cbranch_scc1 L_FR_S
v_add_u32 v5, 16384, v5
v_add_u32 v7, s91, v4
ds_read_b128 v[136:139], v5 offset:0
ds_read_b64 v[120:121], v7 offset:0
ds_read_b64 v[122:123], v7 offset:320
ds_read_b128 v[140:143], v5 offset:1024
ds_read_b64 v[124:125], v7 offset:16
ds_read_b64 v[126:127], v7 offset:336
L_FR_S:
v_and_b32 v4, 31, v0
s_lshl_b32 s83, s81, 5
v_add_u32 v4, s83, v4
v_lshlrev_b32 v4, 3, v4
v_add_u32 v4, 158976, v4
ds_read_b64 v[10:11], v4
s_mov_b32 s32, s64
s_mov_b32 s33, s65
s_mov_b32 s34, 5242880
s_mov_b32 s35, 0x20000
s_mov_b32 s94, 0x00003f80
s_mov_b32 s95, 0x3f800000
v_and_b32 v3, 16, v0
v_sub_u32 v6, v2, v3
v_mul_u32_u24 v6, 2560, v6
v_lshl_add_u32 v6, v3, 1, v6
v_lshrrev_b32 v3, 5, v0
v_lshl_add_u32 v6, v3, 4, v6
v_min_u32 v12, 5, v0
v_lshlrev_b32 v13, 2, v12
v_add_u32 v14, 120, v13
v_cmp_gt_u32 vcc, 2, v12
s_nop 1
v_cndmask_b32 v13, v14, v13, vcc
s_mov_b32 s80, 65536
L_CP_S:
buffer_load_dword v14, v13, s[12:15], s82 offen sc1
s_waitcnt vmcnt(0)
v_cmp_ne_u32 vcc, s11, v14
s_cbranch_vccz L_FP_S
s_sleep 4
s_sub_u32 s80, s80, 1
s_cmp_lg_u32 s80, 0
s_cbranch_scc1 L_CP_S
L_FP_S:
buffer_load_dwordx4 v[88:91], v1, s[12:15], s85 offen
buffer_load_dwordx4 v[92:95], v1, s[12:15], s86 offen
s_add_u32 s83, s86, 10240
buffer_load_dwordx4 v[96:99], v1, s[12:15], s83 offen
s_cmp_ge_u32 s3, 2
s_cbranch_scc1 L_FI_S
s_add_u32 s85, s85, 8192
s_add_u32 s86, s86, 8192
buffer_load_dwordx4 v[100:103], v1, s[12:15], s85 offen
buffer_load_dwordx4 v[104:107], v1, s[12:15], s86 offen
s_add_u32 s83, s86, 10240
buffer_load_dwordx4 v[108:111], v1, s[12:15], s83 offen
L_FI_S:
s_waitcnt lgkmcnt(0)
v_mul_f32 v12, v10, v11
v_sub_f32 v12, 0, v12
v_mul_f32 v13, v11, v11
s_cmp_lt_u32 s3, 2
s_cbranch_scc1 L_F2_S
s_waitcnt vmcnt(0)
s_branch L_F3_S
L_F2_S:
s_waitcnt vmcnt(3)
L_F3_S:
v_dot2_f32_bf16 v128, v88, s94, v128
v_dot2_f32_bf16 v129, v88, s95, v129
v_dot2_f32_bf16 v130, v89, s94, v130
v_dot2_f32_bf16 v131, v89, s95, v131
v_dot2_f32_bf16 v40, v92, s94, 0
v_dot2_f32_bf16 v41, v92, s95, 0
v_dot2_f32_bf16 v42, v93, s94, 0
v_dot2_f32_bf16 v43, v93, s95, 0
v_dot2_f32_bf16 v40, v96, s94, v40
v_dot2_f32_bf16 v41, v96, s95, v41
v_dot2_f32_bf16 v42, v97, s94, v42
v_dot2_f32_bf16 v43, v97, s95, v43
v_lshlrev_b32 v44, 16, v16
v_and_b32 v45, 0xffff0000, v16
v_lshlrev_b32 v46, 16, v17
v_and_b32 v47, 0xffff0000, v17
v_lshlrev_b32 v48, 16, v112
v_and_b32 v49, 0xffff0000, v112
v_lshlrev_b32 v50, 16, v113
v_and_b32 v51, 0xffff0000, v113
v_lshlrev_b32 v52, 16, v114
v_and_b32 v53, 0xffff0000, v114
v_lshlrev_b32 v54, 16, v115
v_and_b32 v55, 0xffff0000, v115
v_fma_f32 v56, v44, v11, v12
v_fma_f32 v57, v45, v11, v12
v_fma_f32 v58, v46, v11, v12
v_fma_f32 v59, v47, v11, v12
v_fmac_f32 v128, v56, v48
v_fmac_f32 v129, v57, v49
v_fmac_f32 v130, v58, v50
v_fmac_f32 v131, v59, v51
v_fma_f32 v40, v40, v13, v52
v_fma_f32 v41, v41, v13, v53
v_fma_f32 v42, v42, v13, v54
v_fma_f32 v43, v43, v13, v55
v_mul_f32 v56, 0xbfb8aa3b, v40
v_mul_f32 v57, 0xbfb8aa3b, v41
v_mul_f32 v58, 0xbfb8aa3b, v42
v_mul_f32 v59, 0xbfb8aa3b, v43
v_exp_f32 v56, v56
v_exp_f32 v57, v57
v_exp_f32 v58, v58
v_exp_f32 v59, v59
v_add_f32 v56, 1.0, v56
v_add_f32 v57, 1.0, v57
v_add_f32 v58, 1.0, v58
v_add_f32 v59, 1.0, v59
v_rcp_f32 v56, v56
v_rcp_f32 v57, v57
v_rcp_f32 v58, v58
v_rcp_f32 v59, v59
v_mul_f32 v40, v40, v56
v_mul_f32 v41, v41, v57
v_mul_f32 v42, v42, v58
v_mul_f32 v43, v43, v59
v_fma_f32 v60, v128, v40, v44
v_fma_f32 v61, v129, v41, v45
v_fma_f32 v62, v130, v42, v46
v_fma_f32 v63, v131, v43, v47
s_add_u32 s83, s92, s90
s_lshl_b32 s83, s83, 1
v_dot2_f32_bf16 v132, v90, s94, v132
v_dot2_f32_bf16 v133, v90, s95, v133
v_dot2_f32_bf16 v134, v91, s94, v134
v_dot2_f32_bf16 v135, v91, s95, v135
v_dot2_f32_bf16 v40, v94, s94, 0
v_dot2_f32_bf16 v41, v94, s95, 0
v_dot2_f32_bf16 v42, v95, s94, 0
v_dot2_f32_bf16 v43, v95, s95, 0
v_dot2_f32_bf16 v40, v98, s94, v40
v_dot2_f32_bf16 v41, v98, s95, v41
v_dot2_f32_bf16 v42, v99, s94, v42
v_dot2_f32_bf16 v43, v99, s95, v43
v_lshlrev_b32 v44, 16, v18
v_and_b32 v45, 0xffff0000, v18
v_lshlrev_b32 v46, 16, v19
v_and_b32 v47, 0xffff0000, v19
v_lshlrev_b32 v48, 16, v116
v_and_b32 v49, 0xffff0000, v116
v_lshlrev_b32 v50, 16, v117
v_and_b32 v51, 0xffff0000, v117
v_lshlrev_b32 v52, 16, v118
v_and_b32 v53, 0xffff0000, v118
v_lshlrev_b32 v54, 16, v119
v_and_b32 v55, 0xffff0000, v119
v_fma_f32 v56, v44, v11, v12
v_fma_f32 v57, v45, v11, v12
v_fma_f32 v58, v46, v11, v12
v_fma_f32 v59, v47, v11, v12
v_fmac_f32 v132, v56, v48
v_fmac_f32 v133, v57, v49
v_fmac_f32 v134, v58, v50
v_fmac_f32 v135, v59, v51
v_fma_f32 v40, v40, v13, v52
v_fma_f32 v41, v41, v13, v53
v_fma_f32 v42, v42, v13, v54
v_fma_f32 v43, v43, v13, v55
v_mul_f32 v56, 0xbfb8aa3b, v40
v_mul_f32 v57, 0xbfb8aa3b, v41
v_mul_f32 v58, 0xbfb8aa3b, v42
v_mul_f32 v59, 0xbfb8aa3b, v43
v_exp_f32 v56, v56
v_exp_f32 v57, v57
v_exp_f32 v58, v58
v_exp_f32 v59, v59
v_add_f32 v56, 1.0, v56
v_add_f32 v57, 1.0, v57
v_add_f32 v58, 1.0, v58
v_add_f32 v59, 1.0, v59
v_rcp_f32 v56, v56
v_rcp_f32 v57, v57
v_rcp_f32 v58, v58
v_rcp_f32 v59, v59
v_mul_f32 v40, v40, v56
v_mul_f32 v41, v41, v57
v_mul_f32 v42, v42, v58
v_mul_f32 v43, v43, v59
v_fma_f32 v64, v132, v40, v44
v_fma_f32 v65, v133, v41, v45
v_fma_f32 v66, v134, v42, v46
v_fma_f32 v67, v135, v43, v47
s_add_u32 s82, s83, 40960
s_nop 1
v_permlane16_swap_b32 v60, v64
v_permlane16_swap_b32 v61, v65
v_permlane16_swap_b32 v62, v66
v_permlane16_swap_b32 v63, v67
buffer_store_dwordx4 v[60:63], v6, s[32:35], s83 offen nt
buffer_store_dwordx4 v[64:67], v6, s[32:35], s82 offen nt
s_cmp_ge_u32 s3, 2
s_cbranch_scc1 L_FE_S
s_waitcnt vmcnt(2)
v_dot2_f32_bf16 v136, v100, s94, v136
v_dot2_f32_bf16 v137, v100, s95, v137
v_dot2_f32_bf16 v138, v101, s94, v138
v_dot2_f32_bf16 v139, v101, s95, v139
v_dot2_f32_bf16 v40, v104, s94, 0
v_dot2_f32_bf16 v41, v104, s95, 0
v_dot2_f32_bf16 v42, v105, s94, 0
v_dot2_f32_bf16 v43, v105, s95, 0
v_dot2_f32_bf16 v40, v108, s94, v40
v_dot2_f32_bf16 v41, v108, s95, v41
v_dot2_f32_bf16 v42, v109, s94, v42
v_dot2_f32_bf16 v43, v109, s95, v43
v_lshlrev_b32 v44, 16, v20
v_and_b32 v45, 0xffff0000, v20
v_lshlrev_b32 v46, 16, v21
v_and_b32 v47, 0xffff0000, v21
v_lshlrev_b32 v48, 16, v120
v_and_b32 v49, 0xffff0000, v120
v_lshlrev_b32 v50, 16, v121
v_and_b32 v51, 0xffff0000, v121
v_lshlrev_b32 v52, 16, v122
v_and_b32 v53, 0xffff0000, v122
v_lshlrev_b32 v54, 16, v123
v_and_b32 v55, 0xffff0000, v123
v_fma_f32 v56, v44, v11, v12
v_fma_f32 v57, v45, v11, v12
v_fma_f32 v58, v46, v11, v12
v_fma_f32 v59, v47, v11, v12
v_fmac_f32 v136, v56, v48
v_fmac_f32 v137, v57, v49
v_fmac_f32 v138, v58, v50
v_fmac_f32 v139, v59, v51
v_fma_f32 v40, v40, v13, v52
v_fma_f32 v41, v41, v13, v53
v_fma_f32 v42, v42, v13, v54
v_fma_f32 v43, v43, v13, v55
v_mul_f32 v56, 0xbfb8aa3b, v40
v_mul_f32 v57, 0xbfb8aa3b, v41
v_mul_f32 v58, 0xbfb8aa3b, v42
v_mul_f32 v59, 0xbfb8aa3b, v43
v_exp_f32 v56, v56
v_exp_f32 v57, v57
v_exp_f32 v58, v58
v_exp_f32 v59, v59
v_add_f32 v56, 1.0, v56
v_add_f32 v57, 1.0, v57
v_add_f32 v58, 1.0, v58
v_add_f32 v59, 1.0, v59
v_rcp_f32 v56, v56
v_rcp_f32 v57, v57
v_rcp_f32 v58, v58
v_rcp_f32 v59, v59
v_mul_f32 v40, v40, v56
v_mul_f32 v41, v41, v57
v_mul_f32 v42, v42, v58
v_mul_f32 v43, v43, v59
v_fma_f32 v60, v136, v40, v44
v_fma_f32 v61, v137, v41, v45
v_fma_f32 v62, v138, v42, v46
v_fma_f32 v63, v139, v43, v47
s_add_u32 s83, s92, s91
s_lshl_b32 s83, s83, 1
v_dot2_f32_bf16 v140, v102, s94, v140
v_dot2_f32_bf16 v141, v102, s95, v141
v_dot2_f32_bf16 v142, v103, s94, v142
v_dot2_f32_bf16 v143, v103, s95, v143
v_dot2_f32_bf16 v40, v106, s94, 0
v_dot2_f32_bf16 v41, v106, s95, 0
v_dot2_f32_bf16 v42, v107, s94, 0
v_dot2_f32_bf16 v43, v107, s95, 0
v_dot2_f32_bf16 v40, v110, s94, v40
v_dot2_f32_bf16 v41, v110, s95, v41
v_dot2_f32_bf16 v42, v111, s94, v42
v_dot2_f32_bf16 v43, v111, s95, v43
v_lshlrev_b32 v44, 16, v22
v_and_b32 v45, 0xffff0000, v22
v_lshlrev_b32 v46, 16, v23
v_and_b32 v47, 0xffff0000, v23
v_lshlrev_b32 v48, 16, v124
v_and_b32 v49, 0xffff0000, v124
v_lshlrev_b32 v50, 16, v125
v_and_b32 v51, 0xffff0000, v125
v_lshlrev_b32 v52, 16, v126
v_and_b32 v53, 0xffff0000, v126
v_lshlrev_b32 v54, 16, v127
v_and_b32 v55, 0xffff0000, v127
v_fma_f32 v56, v44, v11, v12
v_fma_f32 v57, v45, v11, v12
v_fma_f32 v58, v46, v11, v12
v_fma_f32 v59, v47, v11, v12
v_fmac_f32 v140, v56, v48
v_fmac_f32 v141, v57, v49
v_fmac_f32 v142, v58, v50
v_fmac_f32 v143, v59, v51
v_fma_f32 v40, v40, v13, v52
v_fma_f32 v41, v41, v13, v53
v_fma_f32 v42, v42, v13, v54
v_fma_f32 v43, v43, v13, v55
v_mul_f32 v56, 0xbfb8aa3b, v40
v_mul_f32 v57, 0xbfb8aa3b, v41
v_mul_f32 v58, 0xbfb8aa3b, v42
v_mul_f32 v59, 0xbfb8aa3b, v43
v_exp_f32 v56, v56
v_exp_f32 v57, v57
v_exp_f32 v58, v58
v_exp_f32 v59, v59
v_add_f32 v56, 1.0, v56
v_add_f32 v57, 1.0, v57
v_add_f32 v58, 1.0, v58
v_add_f32 v59, 1.0, v59
v_rcp_f32 v56, v56
v_rcp_f32 v57, v57
v_rcp_f32 v58, v58
v_rcp_f32 v59, v59
v_mul_f32 v40, v40, v56
v_mul_f32 v41, v41, v57
v_mul_f32 v42, v42, v58
v_mul_f32 v43, v43, v59
v_fma_f32 v64, v140, v40, v44
v_fma_f32 v65, v141, v41, v45
v_fma_f32 v66, v142, v42, v46
v_fma_f32 v67, v143, v43, v47
s_add_u32 s82, s83, 40960
s_nop 1
v_permlane16_swap_b32 v60, v64
v_permlane16_swap_b32 v61, v65
v_permlane16_swap_b32 v62, v66
v_permlane16_swap_b32 v63, v67
buffer_store_dwordx4 v[60:63], v6, s[32:35], s83 offen nt
buffer_store_dwordx4 v[64:67], v6, s[32:35], s82 offen nt
L_FE_S:
s_endpgm
L_CG:
s_mov_b32 s28, s56
s_mov_b32 s29, s57
s_mov_b32 s30, 1966080
s_mov_b32 s31, 0x20000
s_mul_i32 s70, s5, 40
s_mul_i32 s71, s3, 5
s_add_u32 s70, s70, s71
s_mul_i32 s70, s70, 3072
s_mul_i32 s71, s6, 384
s_add_u32 s70, s70, s71
v_lshlrev_b32 v18, 3, v0
s_mov_b32 exec_lo, -1
s_mov_b32 exec_hi, 0xffff
buffer_load_dwordx2 v[24:25], v18, s[28:31], s70 offen
s_add_u32 s70, s70, 3072
buffer_load_dwordx2 v[26:27], v18, s[28:31], s70 offen
s_add_u32 s70, s70, 3072
buffer_load_dwordx2 v[28:29], v18, s[28:31], s70 offen
s_add_u32 s70, s70, 3072
buffer_load_dwordx2 v[30:31], v18, s[28:31], s70 offen
s_add_u32 s70, s70, 3072
buffer_load_dwordx2 v[32:33], v18, s[28:31], s70 offen
s_mov_b64 exec, -1
s_waitcnt vmcnt(5)
v_readfirstlane_b32 s11, v3
s_mul_i32 s11, s11, 1664525
s_add_u32 s11, s11, 1013904223
s_mov_b32 s70, 0x3f803f80
v_mov_b32 v14, 0
v_dot2_f32_bf16 v14, v4, s70, v14
s_nop 2
v_dot2_f32_bf16 v14, v5, s70, v14
s_nop 2
v_dot2_f32_bf16 v14, v6, s70, v14
s_nop 2
v_dot2_f32_bf16 v14, v7, s70, v14
s_nop 2
v_dot2_f32_bf16 v14, v8, s70, v14
s_nop 2
v_add_f32_dpp v14, v14, v14 row_shr:1 row_mask:0xf bank_mask:0xf bound_ctrl:1
s_nop 1
v_add_f32_dpp v14, v14, v14 row_shr:2 row_mask:0xf bank_mask:0xf bound_ctrl:1
s_nop 1
v_add_f32_dpp v14, v14, v14 row_shr:4 row_mask:0xf bank_mask:0xf bound_ctrl:1
s_nop 1
v_add_f32_dpp v14, v14, v14 row_shr:8 row_mask:0xf bank_mask:0xf bound_ctrl:1
s_nop 1
v_add_f32_dpp v14, v14, v14 row_bcast:15 row_mask:0xa bank_mask:0xf
s_nop 1
v_add_f32_dpp v14, v14, v14 row_bcast:31 row_mask:0xc bank_mask:0xf
s_nop 0
v_readlane_b32 s71, v14, 63
v_mov_b32 v15, 0x3acccccd
s_nop 0
v_mul_f32 v14, s71, v15
v_mov_b32 v15, 0
v_lshlrev_b32 v16, 16, v4
v_and_b32 v17, 0xffff0000, v4
v_sub_f32 v16, v16, v14
v_sub_f32 v17, v17, v14
v_fmac_f32 v15, v16, v16
v_fmac_f32 v15, v17, v17
v_lshlrev_b32 v16, 16, v5
v_and_b32 v17, 0xffff0000, v5
v_sub_f32 v16, v16, v14
v_sub_f32 v17, v17, v14
v_fmac_f32 v15, v16, v16
v_fmac_f32 v15, v17, v17
v_lshlrev_b32 v16, 16, v6
v_and_b32 v17, 0xffff0000, v6
v_sub_f32 v16, v16, v14
v_sub_f32 v17, v17, v14
v_fmac_f32 v15, v16, v16
v_fmac_f32 v15, v17, v17
v_lshlrev_b32 v16, 16, v7
v_and_b32 v17, 0xffff0000, v7
v_sub_f32 v16, v16, v14
v_sub_f32 v17, v17, v14
v_fmac_f32 v15, v16, v16
v_fmac_f32 v15, v17, v17
v_lshlrev_b32 v16, 16, v8
v_and_b32 v17, 0xffff0000, v8
v_sub_f32 v16, v16, v14
v_sub_f32 v17, v17, v14
v_fmac_f32 v15, v16, v16
v_fmac_f32 v15, v17, v17
s_nop 1
v_add_f32_dpp v15, v15, v15 row_shr:1 row_mask:0xf bank_mask:0xf bound_ctrl:1
s_nop 1
v_add_f32_dpp v15, v15, v15 row_shr:2 row_mask:0xf bank_mask:0xf bound_ctrl:1
s_nop 1
v_add_f32_dpp v15, v15, v15 row_shr:4 row_mask:0xf bank_mask:0xf bound_ctrl:1
s_nop 1
v_add_f32_dpp v15, v15, v15 row_shr:8 row_mask:0xf bank_mask:0xf bound_ctrl:1
s_nop 1
v_add_f32_dpp v15, v15, v15 row_bcast:15 row_mask:0xa bank_mask:0xf
s_nop 1
v_add_f32_dpp v15, v15, v15 row_bcast:31 row_mask:0xc bank_mask:0xf
s_nop 0
v_readlane_b32 s71, v15, 63
v_mov_b32 v15, 0x3acccccd
v_mov_b32 v16, 0x3727c5ac
v_fma_f32 v15, s71, v15, v16
v_rsq_f32 v15, v15
v_mov_b32 v16, v14
v_mov_b32 v17, s11
v_mov_b32 v18, v15
v_mov_b32 v19, s11
s_lshl_b32 s71, s74, 4
s_add_u32 s71, s71, 8192
s_mov_b64 exec, 1
buffer_store_dwordx4 v[16:19], off, s[12:15], s71 sc1
s_mov_b64 exec, -1
s_waitcnt vmcnt(1)
s_mov_b32 s70, 0x00003f80
s_mov_b32 s71, 0x3f800000
v_mov_b32 v36, 0
v_mov_b32 v37, 0
v_mov_b32 v38, 0
v_mov_b32 v39, 0
v_dot2_f32_bf16 v36, v24, s70, v36
v_dot2_f32_bf16 v37, v24, s71, v37
v_dot2_f32_bf16 v38, v25, s70, v38
v_dot2_f32_bf16 v39, v25, s71, v39
v_dot2_f32_bf16 v36, v26, s70, v36
v_dot2_f32_bf16 v37, v26, s71, v37
v_dot2_f32_bf16 v38, v27, s70, v38
v_dot2_f32_bf16 v39, v27, s71, v39
v_dot2_f32_bf16 v36, v28, s70, v36
v_dot2_f32_bf16 v37, v28, s71, v37
v_dot2_f32_bf16 v38, v29, s70, v38
v_dot2_f32_bf16 v39, v29, s71, v39
v_dot2_f32_bf16 v36, v30, s70, v36
v_dot2_f32_bf16 v37, v30, s71, v37
v_dot2_f32_bf16 v38, v31, s70, v38
v_dot2_f32_bf16 v39, v31, s71, v39
v_dot2_f32_bf16 v36, v32, s70, v36
v_dot2_f32_bf16 v37, v32, s71, v37
v_dot2_f32_bf16 v38, v33, s70, v38
v_dot2_f32_bf16 v39, v33, s71, v39
s_cmp_lg_u32 s3, 0
s_cbranch_scc1 L_XCC_10
s_getreg_b32 s70, hwreg(HW_REG_XCC_ID, 0, 4)
s_lshl_b32 s71, s2, 3
s_add_u32 s71, s71, 57344
v_mov_b32 v14, s70
v_mov_b32 v15, s11
s_mov_b64 exec, 1
buffer_store_dwordx2 v[14:15], off, s[12:15], s71 sc1
s_mov_b64 exec, -1
L_XCC_10:
s_mul_i32 s70, s3, 768
s_add_u32 s70, s70, 122880
v_add_u32 v18, s70, v1
s_mov_b32 exec_lo, -1
s_mov_b32 exec_hi, 0xffff
ds_write_b128 v18, v[36:39]
s_mov_b64 exec, -1
s_lshr_b32 s75, s2, 1
s_lshl_b32 s70, s3, 7
s_add_u32 s75, s75, s70
s_cmp_ge_u32 s75, 200
s_cbranch_scc1 L_NOREP1_11
s_mul_i32 s76, s75, 6554
s_lshr_b32 s76, s76, 16
s_mul_i32 s77, s76, 10
s_sub_u32 s77, s75, s77
s_mul_i32 s78, s76, 40960
s_lshl_b32 s79, s77, 7
s_add_u32 s78, s78, s79
s_mov_b32 s20, s46
s_mov_b32 s21, s47
s_mov_b32 s22, 819200
s_mov_b32 s23, 0x20000
s_mov_b32 s24, s48
s_mov_b32 s25, s49
s_mov_b32 s26, 819200
s_mov_b32 s27, 0x20000
v_lshrrev_b32 v9, 3, v0
v_and_b32 v10, 7, v0
v_xor_b32 v10, v10, v9
v_lshlrev_b32 v10, 4, v10
v_mul_u32_u24 v9, 1280, v9
v_add_u32 v9, v9, v10
s_lshl_b32 s79, s3, 13
s_add_u32 m0, s79, 131072
s_mov_b32 s79, s78
buffer_load_dwordx4 v9, s[20:23], s79 offen lds
s_add_u32 m0, m0, 1024
s_add_u32 s79, s79, 10240
buffer_load_dwordx4 v9, s[20:23], s79 offen lds
s_add_u32 m0, m0, 1024
s_add_u32 s79, s79, 10240
buffer_load_dwordx4 v9, s[20:23], s79 offen lds
s_add_u32 m0, m0, 1024
s_add_u32 s79, s79, 10240
buffer_load_dwordx4 v9, s[20:23], s79 offen lds
s_add_u32 m0, m0, 1024
s_add_u32 s79, s79, 10240
s_mov_b32 s79, s78
buffer_load_dwordx4 v9, s[24:27], s79 offen lds
s_add_u32 m0, m0, 1024
s_add_u32 s79, s79, 10240
buffer_load_dwordx4 v9, s[24:27], s79 offen lds
s_add_u32 m0, m0, 1024
s_add_u32 s79, s79, 10240
buffer_load_dwordx4 v9, s[24:27], s79 offen lds
s_add_u32 m0, m0, 1024
s_add_u32 s79, s79, 10240
buffer_load_dwordx4 v9, s[24:27], s79 offen lds
s_add_u32 m0, m0, 1024
s_add_u32 s79, s79, 10240
L_NOREP1_11:
v_and_b32 v12, 31, v0
v_bfe_u32 v13, v12, 1, 3
s_lshl_b32 s73, s7, 5
v_add_u32 v12, s73, v12
v_lshlrev_b32 v12, 7, v12
v_lshrrev_b32 v14, 5, v0
v_xor_b32 v13, v13, v14
v_lshl_add_u32 v12, v13, 4, v12
v_add_u32 v4, 81920, v12
v_xor_b32 v5, 32, v4
v_xor_b32 v6, 64, v4
v_xor_b32 v7, 96, v4
v_bfe_u32 v12, v0, 2, 2
v_lshrrev_b32 v13, 5, v0
v_lshl_add_u32 v13, v13, 3, v12
v_mul_u32_u24 v13, 384, v13
v_bfe_u32 v14, v0, 4, 1
v_lshl_add_u32 v13, v14, 5, v13
v_and_b32 v14, 3, v0
v_lshl_add_u32 v13, v14, 3, v13
v_add_u32 v13, 98304, v13
v_bfe_u32 v14, v0, 3, 1
s_mul_i32 s73, s8, 3
s_add_u32 s73, s73, 0
v_xor_b32 v15, s73, v14
v_lshl_add_u32 v8, v15, 6, v13
s_mul_i32 s73, s8, 3
s_add_u32 s73, s73, 1
v_xor_b32 v15, s73, v14
v_lshl_add_u32 v9, v15, 6, v13
s_mul_i32 s73, s8, 3
s_add_u32 s73, s73, 2
v_xor_b32 v15, s73, v14
v_lshl_add_u32 v10, v15, 6, v13
v_mov_b32 v48, 0
v_mov_b32 v49, 0
v_mov_b32 v50, 0
v_mov_b32 v51, 0
v_mov_b32 v52, 0
v_mov_b32 v53, 0
v_mov_b32 v54, 0
v_mov_b32 v55, 0
v_mov_b32 v56, 0
v_mov_b32 v57, 0
v_mov_b32 v58, 0
v_mov_b32 v59, 0
v_mov_b32 v60, 0
v_mov_b32 v61, 0
v_mov_b32 v62, 0
v_mov_b32 v63, 0
v_mov_b32 v64, 0
v_mov_b32 v65, 0
v_mov_b32 v66, 0
v_mov_b32 v67, 0
v_mov_b32 v68, 0
v_mov_b32 v69, 0
v_mov_b32 v70, 0
v_mov_b32 v71, 0
v_mov_b32 v72, 0
v_mov_b32 v73, 0
v_mov_b32 v74, 0
v_mov_b32 v75, 0
v_mov_b32 v76, 0
v_mov_b32 v77, 0
v_mov_b32 v78, 0
v_mov_b32 v79, 0
v_mov_b32 v80, 0
v_mov_b32 v81, 0
v_mov_b32 v82, 0
v_mov_b32 v83, 0
v_mov_b32 v84, 0
v_mov_b32 v85, 0
v_mov_b32 v86, 0
v_mov_b32 v87, 0
v_mov_b32 v88, 0
v_mov_b32 v89, 0
v_mov_b32 v90, 0
v_mov_b32 v91, 0
v_mov_b32 v92, 0
v_mov_b32 v93, 0
v_mov_b32 v94, 0
v_mov_b32 v95, 0
s_waitcnt lgkmcnt(0)
s_barrier
ds_read_b128 v[16:19], v4
ds_read_b64_tr_b16 v[20:21], v8 offset:0
ds_read_b64_tr_b16 v[22:23], v8 offset:1536
ds_read_b64_tr_b16 v[24:25], v9 offset:0
ds_read_b64_tr_b16 v[26:27], v9 offset:1536
ds_read_b64_tr_b16 v[28:29], v10 offset:0
ds_read_b64_tr_b16 v[30:31], v10 offset:1536
s_mul_i32 s70, s3, 96
s_add_u32 s70, s70, 122880
v_lshl_add_u32 v12, v0, 2, s70
s_mov_b32 exec_lo, 0xffffff
s_mov_b32 exec_hi, 0
ds_read_b32 v108, v12 offset:0
ds_read_b32 v109, v12 offset:768
ds_read_b32 v110, v12 offset:1536
ds_read_b32 v111, v12 offset:2304
ds_read_b32 v112, v12 offset:3072
ds_read_b32 v113, v12 offset:3840
ds_read_b32 v114, v12 offset:4608
ds_read_b32 v115, v12 offset:5376
s_mul_i32 s70, s5, 12288
s_mul_i32 s71, s6, 1536
s_add_u32 s70, s70, s71
s_mul_i32 s71, s3, 192
s_add_u32 s70, s70, s71
s_add_u32 s70, s70, 393216
v_lshlrev_b32 v12, 3, v0
v_mov_b32 v117, s11
s_waitcnt lgkmcnt(0)
v_add_f32 v108, v108, v109
v_add_f32 v110, v110, v111
v_add_f32 v112, v112, v113
v_add_f32 v114, v114, v115
v_add_f32 v108, v108, v110
v_add_f32 v112, v112, v114
v_add_f32 v116, v108, v112
buffer_store_dwordx2 v[116:117], v12, s[12:15], s70 offen sc1
s_mov_b64 exec, -1
s_mov_b32 s70, 0
s_mov_b32 s71, 2
L_P1_G:
s_waitcnt lgkmcnt(0)
v_mfma_f32_32x32x16_bf16 v[48:63], v[20:23], v[16:19], v[48:63]
ds_read_b128 v[32:35], v5
ds_read_b64_tr_b16 v[36:37], v8 offset:6144
ds_read_b64_tr_b16 v[38:39], v8 offset:7680
ds_read_b64_tr_b16 v[40:41], v9 offset:6144
v_mfma_f32_32x32x16_bf16 v[64:79], v[24:27], v[16:19], v[64:79]
ds_read_b64_tr_b16 v[42:43], v9 offset:7680
ds_read_b64_tr_b16 v[44:45], v10 offset:6144
ds_read_b64_tr_b16 v[46:47], v10 offset:7680
v_mfma_f32_32x32x16_bf16 v[80:95], v[28:31], v[16:19], v[80:95]
s_waitcnt lgkmcnt(0)
v_mfma_f32_32x32x16_bf16 v[48:63], v[36:39], v[32:35], v[48:63]
ds_read_b128 v[16:19], v6
ds_read_b64_tr_b16 v[20:21], v8 offset:12288
ds_read_b64_tr_b16 v[22:23], v8 offset:13824
ds_read_b64_tr_b16 v[24:25], v9 offset:12288
v_mfma_f32_32x32x16_bf16 v[64:79], v[40:43], v[32:35], v[64:79]
ds_read_b64_tr_b16 v[26:27], v9 offset:13824
ds_read_b64_tr_b16 v[28:29], v10 offset:12288
ds_read_b64_tr_b16 v[30:31], v10 offset:13824
v_mfma_f32_32x32x16_bf16 v[80:95], v[44:47], v[32:35], v[80:95]
s_waitcnt lgkmcnt(0)
v_mfma_f32_32x32x16_bf16 v[48:63], v[20:23], v[16:19], v[48:63]
ds_read_b128 v[32:35], v7
ds_read_b64_tr_b16 v[36:37], v8 offset:18432
ds_read_b64_tr_b16 v[38:39], v8 offset:19968
ds_read_b64_tr_b16 v[40:41], v9 offset:18432
v_mfma_f32_32x32x16_bf16 v[64:79], v[24:27], v[16:19], v[64:79]
ds_read_b64_tr_b16 v[42:43], v9 offset:19968
ds_read_b64_tr_b16 v[44:45], v10 offset:18432
ds_read_b64_tr_b16 v[46:47], v10 offset:19968
v_mfma_f32_32x32x16_bf16 v[80:95], v[28:31], v[16:19], v[80:95]
s_mov_b32 s72, 40960
s_cmp_eq_u32 s71, 2
s_cselect_b32 s72, 4294885376, s72
s_cselect_b32 s71, -1, s71
s_add_u32 s71, s71, 1
v_add_u32 v4, s72, v4
v_add_u32 v5, s72, v5
v_add_u32 v6, s72, v6
v_add_u32 v7, s72, v7
v_add_u32 v8, s72, v8
v_add_u32 v9, s72, v9
v_add_u32 v10, s72, v10
s_waitcnt lgkmcnt(0)
v_mfma_f32_32x32x16_bf16 v[48:63], v[36:39], v[32:35], v[48:63]
s_cmp_eq_u32 s70, 9
s_cbranch_scc1 L_P1_G_last
s_cmp_lg_u32 s70, 0
s_cbranch_scc1 L_P1_G_nd
s_waitcnt vmcnt(0)
L_P1_G_nd:
s_cmp_lg_u32 s70, 1
s_cbranch_scc1 L_P1_G_nc
s_lshr_b32 s75, s2, 1
s_add_u32 s75, s75, 0
s_mul_i32 s76, s75, 6554
s_lshr_b32 s76, s76, 16
s_mul_i32 s77, s76, 10
s_sub_u32 s77, s75, s77
v_and_b32 v2, 31, v0
v_and_b32 v3, 7, v0
v_lshlrev_b32 v3, 4, v3
v_lshl_add_u32 v2, v2, 7, v3
v_lshrrev_b32 v3, 5, v0
v_lshl_add_u32 v2, v3, 3, v2
v_add_u32 v2, 131072, v2
s_lshl_b32 s78, s3, 4
v_xor_b32 v3, s78, v2
ds_read_b64 v[120:121], v3
ds_read_b64 v[122:123], v3 offset:4096
s_mul_i32 s78, s76, 52
s_lshr_b32 s78, s78, 8
s_mul_i32 s79, s78, 5
s_sub_u32 s79, s76, s79
s_lshl_b32 s78, s78, 2
s_lshl_b32 s79, s79, 10
s_add_u32 s79, s79, 1048576
s_lshl_b32 s77, s77, 3
s_add_u32 s77, s77, s3
s_mov_b32 s84, 0x05040100
s_mov_b32 s85, 0x07060302
v_lshlrev_b32 v2, 4, v0
s_mul_i32 s80, s77, 6554
s_lshr_b32 s80, s80, 16
s_mul_i32 s81, s80, 10
s_sub_u32 s81, s77, s81
s_lshr_b32 s82, s80, 2
s_lshl_b32 s82, s82, 4
s_and_b32 s80, s80, 3
s_add_u32 s82, s82, s80
s_add_u32 s82, s82, s78
s_mul_i32 s82, s82, 51200
s_mul_i32 s83, s81, 5120
s_add_u32 s82, s82, s83
s_add_u32 s82, s82, s79
s_sub_u32 s83, s81, 3
s_cmp_lt_u32 s83, 3
s_cselect_b32 s83, 10240, 0
s_add_u32 s82, s82, s83
s_sub_u32 s83, s81, 6
s_cmp_lt_u32 s83, 2
s_cselect_b32 s83, 15360, 0
s_sub_u32 s82, s82, s83
s_waitcnt lgkmcnt(0)
v_perm_b32 v152, v122, v120, s84
v_perm_b32 v153, v122, v120, s85
v_perm_b32 v154, v123, v121, s84
v_perm_b32 v155, v123, v121, s85
buffer_store_dwordx4 v[152:155], v2, s[12:15], s82 offen sc1
L_NOREP3_12:
s_lshr_b32 s75, s2, 1
s_add_u32 s75, s75, 128
s_cmp_ge_u32 s75, 200
s_cbranch_scc1 L_NOREP3_13
s_mul_i32 s76, s75, 6554
s_lshr_b32 s76, s76, 16
s_mul_i32 s77, s76, 10
s_sub_u32 s77, s75, s77
v_and_b32 v2, 31, v0
v_and_b32 v3, 7, v0
v_lshlrev_b32 v3, 4, v3
v_lshl_add_u32 v2, v2, 7, v3
v_lshrrev_b32 v3, 5, v0
v_lshl_add_u32 v2, v3, 3, v2
v_add_u32 v2, 139264, v2
s_lshl_b32 s78, s3, 4
v_xor_b32 v3, s78, v2
ds_read_b64 v[124:125], v3
ds_read_b64 v[126:127], v3 offset:4096
s_mul_i32 s78, s76, 52
s_lshr_b32 s78, s78, 8
s_mul_i32 s79, s78, 5
s_sub_u32 s79, s76, s79
s_lshl_b32 s78, s78, 2
s_lshl_b32 s79, s79, 10
s_add_u32 s79, s79, 1048576
s_lshl_b32 s77, s77, 3
s_add_u32 s77, s77, s3
s_mov_b32 s84, 0x05040100
s_mov_b32 s85, 0x07060302
v_lshlrev_b32 v2, 4, v0
s_mul_i32 s80, s77, 6554
s_lshr_b32 s80, s80, 16
s_mul_i32 s81, s80, 10
s_sub_u32 s81, s77, s81
s_lshr_b32 s82, s80, 2
s_lshl_b32 s82, s82, 4
s_and_b32 s80, s80, 3
s_add_u32 s82, s82, s80
s_add_u32 s82, s82, s78
s_mul_i32 s82, s82, 51200
s_mul_i32 s83, s81, 5120
s_add_u32 s82, s82, s83
s_add_u32 s82, s82, s79
s_sub_u32 s83, s81, 3
s_cmp_lt_u32 s83, 3
s_cselect_b32 s83, 10240, 0
s_add_u32 s82, s82, s83
s_sub_u32 s83, s81, 6
s_cmp_lt_u32 s83, 2
s_cselect_b32 s83, 15360, 0
s_sub_u32 s82, s82, s83
s_waitcnt lgkmcnt(0)
v_perm_b32 v156, v126, v124, s84
v_perm_b32 v157, v126, v124, s85
v_perm_b32 v158, v127, v125, s84
v_perm_b32 v159, v127, v125, s85
buffer_store_dwordx4 v[156:159], v2, s[12:15], s82 offen sc1
L_NOREP3_13:
L_P1_G_nc:
s_cmp_lg_u32 s70, 3
s_cbranch_scc1 L_P1_G_nw
s_waitcnt vmcnt(0)
L_P1_G_nw:
s_cmp_lg_u32 s70, 5
s_cbranch_scc1 L_P1_G_nt
s_lshr_b32 s73, s2, 3
s_mul_i32 s73, s73, 48
s_mul_i32 s74, s3, 6
s_add_u32 s73, s73, s74
s_mul_i32 s73, s73, 1280
v_min_u32 v2, 59, v0
v_lshlrev_b32 v2, 7, v2
s_mov_b32 s32, s60
s_mov_b32 s33, s61
s_mov_b32 s34, 1966080
s_mov_b32 s35, 0x20000
buffer_load_dword v3, v2, s[32:35], s73 offen
L_P1_G_nt:
s_barrier
s_cmp_lg_u32 s70, 3
s_cbranch_scc1 L_P1_G_nf
s_cmp_lg_u32 s3, 0
s_cbranch_scc1 L_P1_G_nf
v_mov_b32 v2, s11
s_lshl_b32 s73, s2, 2
s_add_u32 s73, s73, 4096
s_mov_b64 exec, 1
buffer_store_dword v2, off, s[12:15], s73 sc1
s_mov_b64 exec, -1
L_P1_G_nf:
ds_read_b128 v[16:19], v4
ds_read_b64_tr_b16 v[20:21], v8 offset:0
ds_read_b64_tr_b16 v[22:23], v8 offset:1536
v_mfma_f32_32x32x16_bf16 v[64:79], v[40:43], v[32:35], v[64:79]
ds_read_b64_tr_b16 v[24:25], v9 offset:0
ds_read_b64_tr_b16 v[26:27], v9 offset:1536
ds_read_b64_tr_b16 v[28:29], v10 offset:0
v_mfma_f32_32x32x16_bf16 v[80:95], v[44:47], v[32:35], v[80:95]
ds_read_b64_tr_b16 v[30:31], v10 offset:1536
s_add_u32 s70, s70, 1
s_branch L_P1_G
L_P1_G_last:
v_mfma_f32_32x32x16_bf16 v[64:79], v[40:43], v[32:35], v[64:79]
v_mfma_f32_32x32x16_bf16 v[80:95], v[44:47], v[32:35], v[80:95]
s_barrier
v_mov_b32 v12, 163712
ds_read_b32 v2, v12
v_and_b32 v12, 31, v0
s_lshl_b32 s73, s7, 5
v_add_u32 v13, s73, v12
v_lshlrev_b32 v13, 4, v13
v_add_u32 v13, 153600, v13
v_mov_b32 v14, 155648
v_cmp_gt_u32 vcc, 32, v0
s_nop 1
v_cndmask_b32 v13, v14, v13, vcc
ds_read_b128 v[16:19], v13
s_mul_i32 s73, s8, 96
v_add_u32 v12, s73, v12
v_lshlrev_b32 v12, 4, v12
v_add_u32 v12, 155904, v12
ds_read_b128 v[20:23], v12 offset:0
ds_read_b128 v[24:27], v12 offset:512
ds_read_b128 v[28:31], v12 offset:1024
s_waitcnt lgkmcnt(0)
v_readfirstlane_b32 s96, v2
v_mfma_f32_32x32x16_bf16 v[48:63], v[20:23], v[16:19], v[48:63]
v_mfma_f32_32x32x16_bf16 v[64:79], v[24:27], v[16:19], v[64:79]
v_mfma_f32_32x32x16_bf16 v[80:95], v[28:31], v[16:19], v[80:95]
s_nop 9
v_max_f32 v48, 0, v48
v_max_f32 v49, 0, v49
v_max_f32 v50, 0, v50
v_max_f32 v51, 0, v51
v_max_f32 v52, 0, v52
v_max_f32 v53, 0, v53
v_max_f32 v54, 0, v54
v_max_f32 v55, 0, v55
v_max_f32 v56, 0, v56
v_max_f32 v57, 0, v57
v_max_f32 v58, 0, v58
v_max_f32 v59, 0, v59
v_max_f32 v60, 0, v60
v_max_f32 v61, 0, v61
v_max_f32 v62, 0, v62
v_max_f32 v63, 0, v63
v_pk_mul_f32 v[48:49], v[48:49], v[48:49]
v_pk_mul_f32 v[50:51], v[50:51], v[50:51]
v_pk_mul_f32 v[52:53], v[52:53], v[52:53]
v_pk_mul_f32 v[54:55], v[54:55], v[54:55]
v_pk_mul_f32 v[56:57], v[56:57], v[56:57]
v_pk_mul_f32 v[58:59], v[58:59], v[58:59]
v_pk_mul_f32 v[60:61], v[60:61], v[60:61]
v_pk_mul_f32 v[62:63], v[62:63], v[62:63]
v_cvt_pk_bf16_f32 v16, v48, v49
v_cvt_pk_bf16_f32 v17, v50, v51
v_cvt_pk_bf16_f32 v18, v52, v53
v_cvt_pk_bf16_f32 v19, v54, v55
v_cvt_pk_bf16_f32 v20, v56, v57
v_cvt_pk_bf16_f32 v21, v58, v59
v_cvt_pk_bf16_f32 v22, v60, v61
v_cvt_pk_bf16_f32 v23, v62, v63
v_max_f32 v64, 0, v64
v_max_f32 v65, 0, v65
v_max_f32 v66, 0, v66
v_max_f32 v67, 0, v67
v_max_f32 v68, 0, v68
v_max_f32 v69, 0, v69
v_max_f32 v70, 0, v70
v_max_f32 v71, 0, v71
v_max_f32 v72, 0, v72
v_max_f32 v73, 0, v73
v_max_f32 v74, 0, v74
v_max_f32 v75, 0, v75
v_max_f32 v76, 0, v76
v_max_f32 v77, 0, v77
v_max_f32 v78, 0, v78
v_max_f32 v79, 0, v79
v_pk_mul_f32 v[64:65], v[64:65], v[64:65]
v_pk_mul_f32 v[66:67], v[66:67], v[66:67]
v_pk_mul_f32 v[68:69], v[68:69], v[68:69]
v_pk_mul_f32 v[70:71], v[70:71], v[70:71]
v_pk_mul_f32 v[72:73], v[72:73], v[72:73]
v_pk_mul_f32 v[74:75], v[74:75], v[74:75]
v_pk_mul_f32 v[76:77], v[76:77], v[76:77]
v_pk_mul_f32 v[78:79], v[78:79], v[78:79]
v_cvt_pk_bf16_f32 v24, v64, v65
v_cvt_pk_bf16_f32 v25, v66, v67
v_cvt_pk_bf16_f32 v26, v68, v69
v_cvt_pk_bf16_f32 v27, v70, v71
v_cvt_pk_bf16_f32 v28, v72, v73
v_cvt_pk_bf16_f32 v29, v74, v75
v_cvt_pk_bf16_f32 v30, v76, v77
v_cvt_pk_bf16_f32 v31, v78, v79
v_max_f32 v80, 0, v80
v_max_f32 v81, 0, v81
v_max_f32 v82, 0, v82
v_max_f32 v83, 0, v83
v_max_f32 v84, 0, v84
v_max_f32 v85, 0, v85
v_max_f32 v86, 0, v86
v_max_f32 v87, 0, v87
v_max_f32 v88, 0, v88
v_max_f32 v89, 0, v89
v_max_f32 v90, 0, v90
v_max_f32 v91, 0, v91
v_max_f32 v92, 0, v92
v_max_f32 v93, 0, v93
v_max_f32 v94, 0, v94
v_max_f32 v95, 0, v95
v_pk_mul_f32 v[80:81], v[80:81], v[80:81]
v_pk_mul_f32 v[82:83], v[82:83], v[82:83]
v_pk_mul_f32 v[84:85], v[84:85], v[84:85]
v_pk_mul_f32 v[86:87], v[86:87], v[86:87]
v_pk_mul_f32 v[88:89], v[88:89], v[88:89]
v_pk_mul_f32 v[90:91], v[90:91], v[90:91]
v_pk_mul_f32 v[92:93], v[92:93], v[92:93]
v_pk_mul_f32 v[94:95], v[94:95], v[94:95]
v_cvt_pk_bf16_f32 v32, v80, v81
v_cvt_pk_bf16_f32 v33, v82, v83
v_cvt_pk_bf16_f32 v34, v84, v85
v_cvt_pk_bf16_f32 v35, v86, v87
v_cvt_pk_bf16_f32 v36, v88, v89
v_cvt_pk_bf16_f32 v37, v90, v91
v_cvt_pk_bf16_f32 v38, v92, v93
v_cvt_pk_bf16_f32 v39, v94, v95
s_lshl_b32 s76, s5, 3
s_add_u32 s76, s76, s6
s_lshl_b32 s76, s76, 2
s_add_u32 s76, s76, s7
s_lshl_b32 s76, s76, 1
s_add_u32 s76, s76, s8
s_mul_i32 s76, s76, 6144
s_add_u32 s76, s76, 9437184
v_lshlrev_b32 v1, 4, v0
s_cmp_eq_u32 s96, 1
s_cbranch_scc1 L_PUBL_14
buffer_store_dwordx4 v[16:19], v1, s[12:15], s76 offen offset:0 sc1
buffer_store_dwordx4 v[20:23], v1, s[12:15], s76 offen offset:1024 sc1
buffer_store_dwordx4 v[24:27], v1, s[12:15], s76 offen offset:2048 sc1
buffer_store_dwordx4 v[28:31], v1, s[12:15], s76 offen offset:3072 sc1
s_add_u32 s76, s76, 4096
buffer_store_dwordx4 v[32:35], v1, s[12:15], s76 offen offset:0 sc1
buffer_store_dwordx4 v[36:39], v1, s[12:15], s76 offen offset:1024 sc1
s_branch L_PUBD_15
L_PUBL_14:
buffer_store_dwordx4 v[16:19], v1, s[12:15], s76 offen offset:0 sc1
buffer_store_dwordx4 v[20:23], v1, s[12:15], s76 offen offset:1024 sc1
buffer_store_dwordx4 v[24:27], v1, s[12:15], s76 offen offset:2048 sc1
buffer_store_dwordx4 v[28:31], v1, s[12:15], s76 offen offset:3072 sc1
s_add_u32 s76, s76, 4096
buffer_store_dwordx4 v[32:35], v1, s[12:15], s76 offen offset:0 sc1
buffer_store_dwordx4 v[36:39], v1, s[12:15], s76 offen offset:1024 sc1
L_PUBD_15:
v_bfe_u32 v12, v0, 2, 2
v_lshrrev_b32 v13, 5, v0
v_lshl_add_u32 v13, v13, 2, v12
v_mul_u32_u24 v13, 320, v13
v_bfe_u32 v14, v0, 4, 1
v_lshl_add_u32 v13, v14, 5, v13
v_and_b32 v14, 3, v0
v_lshl_add_u32 v13, v14, 3, v13
s_mul_i32 s73, s8, 15360
v_add_u32 v4, s73, v13
v_lshlrev_b32 v1, 4, v0
v_add_u32 v8, 122880, v4
v_add_u32 v9, 0, v4
s_barrier
ds_read_b64_tr_b16 v[64:65], v8 offset:0
ds_read_b64_tr_b16 v[66:67], v8 offset:2560
ds_read_b64_tr_b16 v[68:69], v8 offset:64
ds_read_b64_tr_b16 v[70:71], v8 offset:2624
ds_read_b64_tr_b16 v[72:73], v8 offset:128
ds_read_b64_tr_b16 v[74:75], v8 offset:2688
ds_read_b64_tr_b16 v[76:77], v8 offset:192
ds_read_b64_tr_b16 v[78:79], v8 offset:2752
ds_read_b64_tr_b16 v[80:81], v8 offset:256
ds_read_b64_tr_b16 v[82:83], v8 offset:2816
s_waitcnt lgkmcnt(8)
v_mfma_f32_32x32x16_bf16 v[88:103], v[64:67], v[16:19], 0
ds_read_b64_tr_b16 v[84:85], v8 offset:5120
ds_read_b64_tr_b16 v[86:87], v8 offset:7680
s_waitcnt lgkmcnt(8)
v_mfma_f32_32x32x16_bf16 v[104:119], v[68:71], v[16:19], 0
ds_read_b64_tr_b16 v[64:65], v8 offset:5184
ds_read_b64_tr_b16 v[66:67], v8 offset:7744
s_waitcnt lgkmcnt(8)
v_mfma_f32_32x32x16_bf16 v[120:135], v[72:75], v[16:19], 0
ds_read_b64_tr_b16 v[68:69], v8 offset:5248
ds_read_b64_tr_b16 v[70:71], v8 offset:7808
s_waitcnt lgkmcnt(8)
v_mfma_f32_32x32x16_bf16 v[136:151], v[76:79], v[16:19], 0
ds_read_b64_tr_b16 v[72:73], v8 offset:5312
ds_read_b64_tr_b16 v[74:75], v8 offset:7872
s_waitcnt lgkmcnt(8)
v_mfma_f32_32x32x16_bf16 v[152:167], v[80:83], v[16:19], 0
ds_read_b64_tr_b16 v[76:77], v8 offset:5376
ds_read_b64_tr_b16 v[78:79], v8 offset:7936
s_lshl_b32 s77, s5, 1
s_add_u32 s77, s77, s9
s_lshl_b32 s77, s77, 2
s_add_u32 s77, s77, s7
s_lshl_b32 s77, s77, 1
s_add_u32 s77, s77, s8
s_lshl_b32 s77, s77, 7
s_add_u32 s77, s77, 327680
s_lshl_b32 s76, s10, 2
s_add_u32 s76, s76, s77
s_waitcnt vmcnt(0)
v_mov_b32 v2, s11
s_mov_b64 exec, 1
s_cmp_eq_u32 s96, 1
s_cbranch_scc1 L_FLGL_16
buffer_store_dword v2, off, s[12:15], s76 sc1
s_branch L_FLGD_17
L_FLGL_16:
buffer_store_dword v2, off, s[12:15], s76
L_FLGD_17:
s_mov_b64 exec, -1
s_waitcnt lgkmcnt(8)
v_mfma_f32_32x32x16_bf16 v[88:103], v[84:87], v[20:23], v[88:103]
ds_read_b64_tr_b16 v[80:81], v8 offset:10240
ds_read_b64_tr_b16 v[82:83], v8 offset:12800
s_waitcnt lgkmcnt(8)
v_mfma_f32_32x32x16_bf16 v[104:119], v[64:67], v[20:23], v[104:119]
ds_read_b64_tr_b16 v[84:85], v8 offset:10304
ds_read_b64_tr_b16 v[86:87], v8 offset:12864
s_waitcnt lgkmcnt(8)
v_mfma_f32_32x32x16_bf16 v[120:135], v[68:71], v[20:23], v[120:135]
ds_read_b64_tr_b16 v[64:65], v8 offset:10368
ds_read_b64_tr_b16 v[66:67], v8 offset:12928
s_waitcnt lgkmcnt(8)
v_mfma_f32_32x32x16_bf16 v[136:151], v[72:75], v[20:23], v[136:151]
ds_read_b64_tr_b16 v[68:69], v8 offset:10432
ds_read_b64_tr_b16 v[70:71], v8 offset:12992
s_waitcnt lgkmcnt(8)
v_mfma_f32_32x32x16_bf16 v[152:167], v[76:79], v[20:23], v[152:167]
ds_read_b64_tr_b16 v[72:73], v8 offset:10496
ds_read_b64_tr_b16 v[74:75], v8 offset:13056
s_waitcnt lgkmcnt(8)
v_mfma_f32_32x32x16_bf16 v[88:103], v[80:83], v[24:27], v[88:103]
s_waitcnt lgkmcnt(6)
v_mfma_f32_32x32x16_bf16 v[104:119], v[84:87], v[24:27], v[104:119]
s_waitcnt lgkmcnt(0)
s_barrier
v_add_u32 v8, 30720, v4
ds_read_b64_tr_b16 v[76:77], v9 offset:0
ds_read_b64_tr_b16 v[78:79], v9 offset:2560
ds_read_b64_tr_b16 v[80:81], v9 offset:64
ds_read_b64_tr_b16 v[82:83], v9 offset:2624
v_mfma_f32_32x32x16_bf16 v[120:135], v[64:67], v[24:27], v[120:135]
ds_read_b64_tr_b16 v[84:85], v9 offset:128
ds_read_b64_tr_b16 v[86:87], v9 offset:2688
v_mfma_f32_32x32x16_bf16 v[136:151], v[68:71], v[24:27], v[136:151]
ds_read_b64_tr_b16 v[64:65], v9 offset:192
ds_read_b64_tr_b16 v[66:67], v9 offset:2752
v_mfma_f32_32x32x16_bf16 v[152:167], v[72:75], v[24:27], v[152:167]
ds_read_b64_tr_b16 v[68:69], v9 offset:256
ds_read_b64_tr_b16 v[70:71], v9 offset:2816
s_lshl_b32 s79, s5, 1
s_add_u32 s79, s79, s9
s_lshl_b32 s79, s79, 2
s_add_u32 s79, s79, s7
s_lshl_b32 s79, s79, 1
s_add_u32 s79, s79, s8
s_lshl_b32 s79, s79, 7
s_add_u32 s79, s79, 327680
buffer_load_dwordx4 v[12:15], off, s[12:15], s79 sc1
s_add_u32 s73, s10, 1
s_and_b32 s73, s73, 3
s_lshl_b32 s74, s9, 2
s_add_u32 s73, s73, s74
s_lshl_b32 s84, s5, 3
s_add_u32 s84, s84, s73
s_lshl_b32 s84, s84, 2
s_add_u32 s84, s84, s7
s_lshl_b32 s84, s84, 1
s_add_u32 s84, s84, s8
s_mul_i32 s84, s84, 6144
s_add_u32 s84, s84, 9437184
s_add_u32 s87, s84, 4096
s_add_u32 s73, s10, 2
s_and_b32 s73, s73, 3
s_lshl_b32 s74, s9, 2
s_add_u32 s73, s73, s74
s_lshl_b32 s85, s5, 3
s_add_u32 s85, s85, s73
s_lshl_b32 s85, s85, 2
s_add_u32 s85, s85, s7
s_lshl_b32 s85, s85, 1
s_add_u32 s85, s85, s8
s_mul_i32 s85, s85, 6144
s_add_u32 s85, s85, 9437184
s_add_u32 s88, s85, 4096
s_add_u32 s73, s10, 3
s_and_b32 s73, s73, 3
s_lshl_b32 s74, s9, 2
s_add_u32 s73, s73, s74
s_lshl_b32 s86, s5, 3
s_add_u32 s86, s86, s73
s_lshl_b32 s86, s86, 2
s_add_u32 s86, s86, s7
s_lshl_b32 s86, s86, 1
s_add_u32 s86, s86, s8
s_mul_i32 s86, s86, 6144
s_add_u32 s86, s86, 9437184
s_add_u32 s89, s86, 4096
s_waitcnt lgkmcnt(8)
v_mfma_f32_32x32x16_bf16 v[88:103], v[76:79], v[28:31], v[88:103]
ds_read_b64_tr_b16 v[72:73], v9 offset:5120
ds_read_b64_tr_b16 v[74:75], v9 offset:7680
s_add_u32 s81, s9, 2
s_lshl_b32 s82, s5, 7
s_lshl_b32 s83, s81, 5
s_add_u32 s82, s82, s83
v_and_b32 v2, 31, v0
v_add_u32 v2, s82, v2
v_lshrrev_b32 v3, 5, v0
v_lshlrev_b32 v3, 3, v3
v_mul_u32_u24 v6, 1280, v2
v_add_u32 v6, v6, v3
s_add_u32 s82, s3, 0
s_min_u32 s82, s82, 9
s_lshr_b32 s83, s82, 1
s_lshl_b32 s83, s83, 6
s_and_b32 s82, s82, 1
s_lshl_b32 s82, s82, 5
s_add_u32 s90, s82, s83
s_add_u32 s82, s3, 8
s_min_u32 s82, s82, 9
s_lshr_b32 s83, s82, 1
s_lshl_b32 s83, s83, 6
s_and_b32 s82, s82, 1
s_lshl_b32 s82, s82, 5
s_add_u32 s91, s82, s83
s_mul_i32 s92, s10, 320
s_waitcnt lgkmcnt(8)
v_mfma_f32_32x32x16_bf16 v[104:119], v[80:83], v[28:31], v[104:119]
ds_read_b64_tr_b16 v[76:77], v9 offset:5184
ds_read_b64_tr_b16 v[78:79], v9 offset:7744
s_waitcnt lgkmcnt(8)
v_mfma_f32_32x32x16_bf16 v[120:135], v[84:87], v[28:31], v[120:135]
ds_read_b64_tr_b16 v[80:81], v9 offset:5248
ds_read_b64_tr_b16 v[82:83], v9 offset:7808
s_waitcnt lgkmcnt(8)
v_mfma_f32_32x32x16_bf16 v[136:151], v[64:67], v[28:31], v[136:151]
ds_read_b64_tr_b16 v[84:85], v9 offset:5312
ds_read_b64_tr_b16 v[86:87], v9 offset:7872
s_waitcnt lgkmcnt(8)
v_mfma_f32_32x32x16_bf16 v[152:167], v[68:71], v[28:31], v[152:167]
ds_read_b64_tr_b16 v[64:65], v9 offset:5376
ds_read_b64_tr_b16 v[66:67], v9 offset:7936
s_waitcnt vmcnt(0)
s_mov_b32 s80, 65536
L_PF1_G:
v_xor_b32 v12, s11, v12
v_xor_b32 v13, s11, v13
v_xor_b32 v14, s11, v14
v_xor_b32 v15, s11, v15
v_or3_b32 v12, v12, v13, v14
v_or_b32 v12, v12, v15
v_cmp_ne_u32 vcc, 0, v12
s_cbranch_vccz L_PF1_G_ok
s_sub_u32 s80, s80, 1
s_cmp_eq_u32 s80, 0
s_cbranch_scc1 L_PF1_G_ok
buffer_load_dwordx4 v[12:15], off, s[12:15], s79 sc1
s_waitcnt vmcnt(0)
s_branch L_PF1_G
L_PF1_G_ok:
buffer_load_dwordx4 v[40:43], v1, s[12:15], s84 offen offset:0
s_waitcnt lgkmcnt(8)
v_mfma_f32_32x32x16_bf16 v[88:103], v[72:75], v[32:35], v[88:103]
ds_read_b64_tr_b16 v[68:69], v9 offset:10240
ds_read_b64_tr_b16 v[70:71], v9 offset:12800
s_waitcnt lgkmcnt(8)
v_mfma_f32_32x32x16_bf16 v[104:119], v[76:79], v[32:35], v[104:119]
ds_read_b64_tr_b16 v[72:73], v9 offset:10304
ds_read_b64_tr_b16 v[74:75], v9 offset:12864
s_waitcnt lgkmcnt(8)
v_mfma_f32_32x32x16_bf16 v[120:135], v[80:83], v[32:35], v[120:135]
ds_read_b64_tr_b16 v[76:77], v9 offset:10368
ds_read_b64_tr_b16 v[78:79], v9 offset:12928
buffer_load_dwordx4 v[44:47], v1, s[12:15], s84 offen offset:1024
s_waitcnt lgkmcnt(8)
v_mfma_f32_32x32x16_bf16 v[136:151], v[84:87], v[32:35], v[136:151]
ds_read_b64_tr_b16 v[80:81], v9 offset:10432
ds_read_b64_tr_b16 v[82:83], v9 offset:12992
s_waitcnt lgkmcnt(8)
v_mfma_f32_32x32x16_bf16 v[152:167], v[64:67], v[32:35], v[152:167]
ds_read_b64_tr_b16 v[84:85], v9 offset:10496
ds_read_b64_tr_b16 v[86:87], v9 offset:13056
s_waitcnt lgkmcnt(8)
v_mfma_f32_32x32x16_bf16 v[88:103], v[68:71], v[36:39], v[88:103]
buffer_load_dwordx4 v[48:51], v1, s[12:15], s84 offen offset:2048
s_waitcnt lgkmcnt(6)
v_mfma_f32_32x32x16_bf16 v[104:119], v[72:75], v[36:39], v[104:119]
s_waitcnt lgkmcnt(0)
s_barrier
v_add_u32 v9, 61440, v4
ds_read_b64_tr_b16 v[64:65], v8 offset:0
ds_read_b64_tr_b16 v[66:67], v8 offset:2560
ds_read_b64_tr_b16 v[68:69], v8 offset:64
ds_read_b64_tr_b16 v[70:71], v8 offset:2624
v_mfma_f32_32x32x16_bf16 v[120:135], v[76:79], v[36:39], v[120:135]
ds_read_b64_tr_b16 v[72:73], v8 offset:128
ds_read_b64_tr_b16 v[74:75], v8 offset:2688
v_mfma_f32_32x32x16_bf16 v[136:151], v[80:83], v[36:39], v[136:151]
ds_read_b64_tr_b16 v[76:77], v8 offset:192
ds_read_b64_tr_b16 v[78:79], v8 offset:2752
buffer_load_dwordx4 v[52:55], v1, s[12:15], s84 offen offset:3072
v_mfma_f32_32x32x16_bf16 v[152:167], v[84:87], v[36:39], v[152:167]
ds_read_b64_tr_b16 v[80:81], v8 offset:256
ds_read_b64_tr_b16 v[82:83], v8 offset:2816
s_waitcnt vmcnt(3)
s_waitcnt lgkmcnt(8)
v_mfma_f32_32x32x16_bf16 v[88:103], v[64:67], v[40:43], v[88:103]
ds_read_b64_tr_b16 v[84:85], v8 offset:5120
ds_read_b64_tr_b16 v[86:87], v8 offset:7680
s_waitcnt lgkmcnt(8)
v_mfma_f32_32x32x16_bf16 v[104:119], v[68:71], v[40:43], v[104:119]
ds_read_b64_tr_b16 v[64:65], v8 offset:5184
ds_read_b64_tr_b16 v[66:67], v8 offset:7744
buffer_load_dwordx4 v[56:59], v1, s[12:15], s87 offen offset:0
s_waitcnt lgkmcnt(8)
v_mfma_f32_32x32x16_bf16 v[120:135], v[72:75], v[40:43], v[120:135]
ds_read_b64_tr_b16 v[68:69], v8 offset:5248
ds_read_b64_tr_b16 v[70:71], v8 offset:7808
s_waitcnt lgkmcnt(8)
v_mfma_f32_32x32x16_bf16 v[136:151], v[76:79], v[40:43], v[136:151]
ds_read_b64_tr_b16 v[72:73], v8 offset:5312
ds_read_b64_tr_b16 v[74:75], v8 offset:7872
s_waitcnt lgkmcnt(8)
v_mfma_f32_32x32x16_bf16 v[152:167], v[80:83], v[40:43], v[152:167]
ds_read_b64_tr_b16 v[76:77], v8 offset:5376
ds_read_b64_tr_b16 v[78:79], v8 offset:7936
buffer_load_dwordx4 v[60:63], v1, s[12:15], s87 offen offset:1024
s_waitcnt vmcnt(4)
s_waitcnt lgkmcnt(8)
v_mfma_f32_32x32x16_bf16 v[88:103], v[84:87], v[44:47], v[88:103]
ds_read_b64_tr_b16 v[80:81], v8 offset:10240
ds_read_b64_tr_b16 v[82:83], v8 offset:12800
s_waitcnt lgkmcnt(8)
v_mfma_f32_32x32x16_bf16 v[104:119], v[64:67], v[44:47], v[104:119]
ds_read_b64_tr_b16 v[84:85], v8 offset:10304
ds_read_b64_tr_b16 v[86:87], v8 offset:12864
s_waitcnt lgkmcnt(8)
v_mfma_f32_32x32x16_bf16 v[120:135], v[68:71], v[44:47], v[120:135]
ds_read_b64_tr_b16 v[64:65], v8 offset:10368
ds_read_b64_tr_b16 v[66:67], v8 offset:12928
buffer_load_dwordx4 v[16:19], v1, s[12:15], s85 offen offset:0
s_waitcnt lgkmcnt(8)
v_mfma_f32_32x32x16_bf16 v[136:151], v[72:75], v[44:47], v[136:151]
ds_read_b64_tr_b16 v[68:69], v8 offset:10432
ds_read_b64_tr_b16 v[70:71], v8 offset:12992
s_waitcnt lgkmcnt(8)
v_mfma_f32_32x32x16_bf16 v[152:167], v[76:79], v[44:47], v[152:167]
ds_read_b64_tr_b16 v[72:73], v8 offset:10496
ds_read_b64_tr_b16 v[74:75], v8 offset:13056
s_waitcnt vmcnt(4)
s_waitcnt lgkmcnt(8)
v_mfma_f32_32x32x16_bf16 v[88:103], v[80:83], v[48:51], v[88:103]
buffer_load_dwordx4 v[20:23], v1, s[12:15], s85 offen offset:1024
s_waitcnt lgkmcnt(6)
v_mfma_f32_32x32x16_bf16 v[104:119], v[84:87], v[48:51], v[104:119]
s_waitcnt lgkmcnt(0)
s_barrier
v_add_u32 v8, 92160, v4
ds_read_b64_tr_b16 v[76:77], v9 offset:0
ds_read_b64_tr_b16 v[78:79], v9 offset:2560
ds_read_b64_tr_b16 v[80:81], v9 offset:64
ds_read_b64_tr_b16 v[82:83], v9 offset:2624
v_mfma_f32_32x32x16_bf16 v[120:135], v[64:67], v[48:51], v[120:135]
ds_read_b64_tr_b16 v[84:85], v9 offset:128
ds_read_b64_tr_b16 v[86:87], v9 offset:2688
v_mfma_f32_32x32x16_bf16 v[136:151], v[68:71], v[48:51], v[136:151]
ds_read_b64_tr_b16 v[64:65], v9 offset:192
ds_read_b64_tr_b16 v[66:67], v9 offset:2752
buffer_load_dwordx4 v[24:27], v1, s[12:15], s85 offen offset:2048
v_mfma_f32_32x32x16_bf16 v[152:167], v[72:75], v[48:51], v[152:167]
ds_read_b64_tr_b16 v[68:69], v9 offset:256
ds_read_b64_tr_b16 v[70:71], v9 offset:2816
s_waitcnt vmcnt(5)
s_waitcnt lgkmcnt(8)
v_mfma_f32_32x32x16_bf16 v[88:103], v[76:79], v[52:55], v[88:103]
ds_read_b64_tr_b16 v[72:73], v9 offset:5120
ds_read_b64_tr_b16 v[74:75], v9 offset:7680
s_waitcnt lgkmcnt(8)
v_mfma_f32_32x32x16_bf16 v[104:119], v[80:83], v[52:55], v[104:119]
ds_read_b64_tr_b16 v[76:77], v9 offset:5184
ds_read_b64_tr_b16 v[78:79], v9 offset:7744
buffer_load_dwordx4 v[28:31], v1, s[12:15], s85 offen offset:3072
s_waitcnt lgkmcnt(8)
v_mfma_f32_32x32x16_bf16 v[120:135], v[84:87], v[52:55], v[120:135]
ds_read_b64_tr_b16 v[80:81], v9 offset:5248
ds_read_b64_tr_b16 v[82:83], v9 offset:7808
s_waitcnt lgkmcnt(8)
v_mfma_f32_32x32x16_bf16 v[136:151], v[64:67], v[52:55], v[136:151]
ds_read_b64_tr_b16 v[84:85], v9 offset:5312
ds_read_b64_tr_b16 v[86:87], v9 offset:7872
s_waitcnt lgkmcnt(8)
v_mfma_f32_32x32x16_bf16 v[152:167], v[68:71], v[52:55], v[152:167]
ds_read_b64_tr_b16 v[64:65], v9 offset:5376
ds_read_b64_tr_b16 v[66:67], v9 offset:7936
buffer_load_dwordx4 v[32:35], v1, s[12:15], s88 offen offset:0
s_waitcnt vmcnt(6)
s_waitcnt lgkmcnt(8)
v_mfma_f32_32x32x16_bf16 v[88:103], v[72:75], v[56:59], v[88:103]
ds_read_b64_tr_b16 v[68:69], v9 offset:10240
ds_read_b64_tr_b16 v[70:71], v9 offset:12800
s_waitcnt lgkmcnt(8)
v_mfma_f32_32x32x16_bf16 v[104:119], v[76:79], v[56:59], v[104:119]
ds_read_b64_tr_b16 v[72:73], v9 offset:10304
ds_read_b64_tr_b16 v[74:75], v9 offset:12864
s_waitcnt lgkmcnt(8)
v_mfma_f32_32x32x16_bf16 v[120:135], v[80:83], v[56:59], v[120:135]
ds_read_b64_tr_b16 v[76:77], v9 offset:10368
ds_read_b64_tr_b16 v[78:79], v9 offset:12928
buffer_load_dwordx4 v[36:39], v1, s[12:15], s88 offen offset:1024
s_waitcnt lgkmcnt(8)
v_mfma_f32_32x32x16_bf16 v[136:151], v[84:87], v[56:59], v[136:151]
ds_read_b64_tr_b16 v[80:81], v9 offset:10432
ds_read_b64_tr_b16 v[82:83], v9 offset:12992
s_waitcnt lgkmcnt(8)
v_mfma_f32_32x32x16_bf16 v[152:167], v[64:67], v[56:59], v[152:167]
ds_read_b64_tr_b16 v[84:85], v9 offset:10496
ds_read_b64_tr_b16 v[86:87], v9 offset:13056
s_waitcnt vmcnt(6)
s_waitcnt lgkmcnt(8)
v_mfma_f32_32x32x16_bf16 v[88:103], v[68:71], v[60:63], v[88:103]
buffer_load_dwordx4 v[40:43], v1, s[12:15], s86 offen offset:0
s_waitcnt lgkmcnt(6)
v_mfma_f32_32x32x16_bf16 v[104:119], v[72:75], v[60:63], v[104:119]
s_waitcnt lgkmcnt(0)
s_barrier
v_add_u32 v9, 122880, v4
ds_read_b64_tr_b16 v[64:65], v8 offset:0
ds_read_b64_tr_b16 v[66:67], v8 offset:2560
ds_read_b64_tr_b16 v[68:69], v8 offset:64
ds_read_b64_tr_b16 v[70:71], v8 offset:2624
v_mfma_f32_32x32x16_bf16 v[120:135], v[76:79], v[60:63], v[120:135]
ds_read_b64_tr_b16 v[72:73], v8 offset:128
ds_read_b64_tr_b16 v[74:75], v8 offset:2688
v_mfma_f32_32x32x16_bf16 v[136:151], v[80:83], v[60:63], v[136:151]
ds_read_b64_tr_b16 v[76:77], v8 offset:192
ds_read_b64_tr_b16 v[78:79], v8 offset:2752
buffer_load_dwordx4 v[44:47], v1, s[12:15], s86 offen offset:1024
v_mfma_f32_32x32x16_bf16 v[152:167], v[84:87], v[60:63], v[152:167]
ds_read_b64_tr_b16 v[80:81], v8 offset:256
ds_read_b64_tr_b16 v[82:83], v8 offset:2816
s_waitcnt vmcnt(7)
s_waitcnt lgkmcnt(8)
v_mfma_f32_32x32x16_bf16 v[88:103], v[64:67], v[16:19], v[88:103]
ds_read_b64_tr_b16 v[84:85], v8 offset:5120
ds_read_b64_tr_b16 v[86:87], v8 offset:7680
s_waitcnt lgkmcnt(8)
v_mfma_f32_32x32x16_bf16 v[104:119], v[68:71], v[16:19], v[104:119]
ds_read_b64_tr_b16 v[64:65], v8 offset:5184
ds_read_b64_tr_b16 v[66:67], v8 offset:7744
buffer_load_dwordx4 v[48:51], v1, s[12:15], s86 offen offset:2048
s_waitcnt lgkmcnt(8)
v_mfma_f32_32x32x16_bf16 v[120:135], v[72:75], v[16:19], v[120:135]
ds_read_b64_tr_b16 v[68:69], v8 offset:5248
ds_read_b64_tr_b16 v[70:71], v8 offset:7808
s_waitcnt lgkmcnt(8)
v_mfma_f32_32x32x16_bf16 v[136:151], v[76:79], v[16:19], v[136:151]
ds_read_b64_tr_b16 v[72:73], v8 offset:5312
ds_read_b64_tr_b16 v[74:75], v8 offset:7872
s_waitcnt lgkmcnt(8)
v_mfma_f32_32x32x16_bf16 v[152:167], v[80:83], v[16:19], v[152:167]
ds_read_b64_tr_b16 v[76:77], v8 offset:5376
ds_read_b64_tr_b16 v[78:79], v8 offset:7936
buffer_load_dwordx4 v[52:55], v1, s[12:15], s86 offen offset:3072
s_waitcnt vmcnt(8)
s_waitcnt lgkmcnt(8)
v_mfma_f32_32x32x16_bf16 v[88:103], v[84:87], v[20:23], v[88:103]
ds_read_b64_tr_b16 v[80:81], v8 offset:10240
ds_read_b64_tr_b16 v[82:83], v8 offset:12800
s_waitcnt lgkmcnt(8)
v_mfma_f32_32x32x16_bf16 v[104:119], v[64:67], v[20:23], v[104:119]
ds_read_b64_tr_b16 v[84:85], v8 offset:10304
ds_read_b64_tr_b16 v[86:87], v8 offset:12864
s_waitcnt lgkmcnt(8)
v_mfma_f32_32x32x16_bf16 v[120:135], v[68:71], v[20:23], v[120:135]
ds_read_b64_tr_b16 v[64:65], v8 offset:10368
ds_read_b64_tr_b16 v[66:67], v8 offset:12928
buffer_load_dwordx4 v[56:59], v1, s[12:15], s89 offen offset:0
s_waitcnt lgkmcnt(8)
v_mfma_f32_32x32x16_bf16 v[136:151], v[72:75], v[20:23], v[136:151]
ds_read_b64_tr_b16 v[68:69], v8 offset:10432
ds_read_b64_tr_b16 v[70:71], v8 offset:12992
s_waitcnt lgkmcnt(8)
v_mfma_f32_32x32x16_bf16 v[152:167], v[76:79], v[20:23], v[152:167]
ds_read_b64_tr_b16 v[72:73], v8 offset:10496
ds_read_b64_tr_b16 v[74:75], v8 offset:13056
s_waitcnt vmcnt(8)
s_waitcnt lgkmcnt(8)
v_mfma_f32_32x32x16_bf16 v[88:103], v[80:83], v[24:27], v[88:103]
buffer_load_dwordx4 v[60:63], v1, s[12:15], s89 offen offset:1024
s_waitcnt lgkmcnt(6)
v_mfma_f32_32x32x16_bf16 v[104:119], v[84:87], v[24:27], v[104:119]
s_waitcnt lgkmcnt(0)
s_barrier
v_add_u32 v8, 0, v4
ds_read_b64_tr_b16 v[76:77], v9 offset:0
ds_read_b64_tr_b16 v[78:79], v9 offset:2560
ds_read_b64_tr_b16 v[80:81], v9 offset:64
ds_read_b64_tr_b16 v[82:83], v9 offset:2624
v_mfma_f32_32x32x16_bf16 v[120:135], v[64:67], v[24:27], v[120:135]
ds_read_b64_tr_b16 v[84:85], v9 offset:128
ds_read_b64_tr_b16 v[86:87], v9 offset:2688
v_mfma_f32_32x32x16_bf16 v[136:151], v[68:71], v[24:27], v[136:151]
ds_read_b64_tr_b16 v[64:65], v9 offset:192
ds_read_b64_tr_b16 v[66:67], v9 offset:2752
v_mfma_f32_32x32x16_bf16 v[152:167], v[72:75], v[24:27], v[152:167]
ds_read_b64_tr_b16 v[68:69], v9 offset:256
ds_read_b64_tr_b16 v[70:71], v9 offset:2816
s_waitcnt vmcnt(8)
s_waitcnt lgkmcnt(8)
v_mfma_f32_32x32x16_bf16 v[88:103], v[76:79], v[28:31], v[88:103]
ds_read_b64_tr_b16 v[72:73], v9 offset:5120
ds_read_b64_tr_b16 v[74:75], v9 offset:7680
s_waitcnt lgkmcnt(8)
v_mfma_f32_32x32x16_bf16 v[104:119], v[80:83], v[28:31], v[104:119]
ds_read_b64_tr_b16 v[76:77], v9 offset:5184
ds_read_b64_tr_b16 v[78:79], v9 offset:7744
s_waitcnt lgkmcnt(8)
v_mfma_f32_32x32x16_bf16 v[120:135], v[84:87], v[28:31], v[120:135]
ds_read_b64_tr_b16 v[80:81], v9 offset:5248
ds_read_b64_tr_b16 v[82:83], v9 offset:7808
s_waitcnt lgkmcnt(8)
v_mfma_f32_32x32x16_bf16 v[136:151], v[64:67], v[28:31], v[136:151]
ds_read_b64_tr_b16 v[84:85], v9 offset:5312
ds_read_b64_tr_b16 v[86:87], v9 offset:7872
s_waitcnt lgkmcnt(8)
v_mfma_f32_32x32x16_bf16 v[152:167], v[68:71], v[28:31], v[152:167]
ds_read_b64_tr_b16 v[64:65], v9 offset:5376
ds_read_b64_tr_b16 v[66:67], v9 offset:7936
s_waitcnt vmcnt(7)
s_waitcnt lgkmcnt(8)
v_mfma_f32_32x32x16_bf16 v[88:103], v[72:75], v[32:35], v[88:103]
ds_read_b64_tr_b16 v[68:69], v9 offset:10240
ds_read_b64_tr_b16 v[70:71], v9 offset:12800
s_waitcnt lgkmcnt(8)
v_mfma_f32_32x32x16_bf16 v[104:119], v[76:79], v[32:35], v[104:119]
ds_read_b64_tr_b16 v[72:73], v9 offset:10304
ds_read_b64_tr_b16 v[74:75], v9 offset:12864
s_waitcnt lgkmcnt(8)
v_mfma_f32_32x32x16_bf16 v[120:135], v[80:83], v[32:35], v[120:135]
ds_read_b64_tr_b16 v[76:77], v9 offset:10368
ds_read_b64_tr_b16 v[78:79], v9 offset:12928
s_waitcnt lgkmcnt(8)
v_mfma_f32_32x32x16_bf16 v[136:151], v[84:87], v[32:35], v[136:151]
ds_read_b64_tr_b16 v[80:81], v9 offset:10432
ds_read_b64_tr_b16 v[82:83], v9 offset:12992
s_waitcnt lgkmcnt(8)
v_mfma_f32_32x32x16_bf16 v[152:167], v[64:67], v[32:35], v[152:167]
ds_read_b64_tr_b16 v[84:85], v9 offset:10496
ds_read_b64_tr_b16 v[86:87], v9 offset:13056
s_waitcnt vmcnt(6)
s_waitcnt lgkmcnt(8)
v_mfma_f32_32x32x16_bf16 v[88:103], v[68:71], v[36:39], v[88:103]
s_waitcnt lgkmcnt(6)
v_mfma_f32_32x32x16_bf16 v[104:119], v[72:75], v[36:39], v[104:119]
s_waitcnt lgkmcnt(0)
s_barrier
v_add_u32 v9, 30720, v4
ds_read_b64_tr_b16 v[64:65], v8 offset:0
ds_read_b64_tr_b16 v[66:67], v8 offset:2560
ds_read_b64_tr_b16 v[68:69], v8 offset:64
ds_read_b64_tr_b16 v[70:71], v8 offset:2624
v_mfma_f32_32x32x16_bf16 v[120:135], v[76:79], v[36:39], v[120:135]
ds_read_b64_tr_b16 v[72:73], v8 offset:128
ds_read_b64_tr_b16 v[74:75], v8 offset:2688
v_mfma_f32_32x32x16_bf16 v[136:151], v[80:83], v[36:39], v[136:151]
ds_read_b64_tr_b16 v[76:77], v8 offset:192
ds_read_b64_tr_b16 v[78:79], v8 offset:2752
v_mfma_f32_32x32x16_bf16 v[152:167], v[84:87], v[36:39], v[152:167]
ds_read_b64_tr_b16 v[80:81], v8 offset:256
ds_read_b64_tr_b16 v[82:83], v8 offset:2816
s_add_u32 s82, s92, s90
buffer_load_dwordx2 v[16:17], v6, s[16:19], s82 offen offset:0
buffer_load_dwordx2 v[18:19], v6, s[16:19], s82 offen offset:16
s_cmp_ge_u32 s3, 2
s_cbranch_scc1 L_FXL_G
s_add_u32 s82, s92, s91
buffer_load_dwordx2 v[20:21], v6, s[16:19], s82 offen offset:0
buffer_load_dwordx2 v[22:23], v6, s[16:19], s82 offen offset:16
L_FXL_G:
s_waitcnt vmcnt(5)
s_waitcnt lgkmcnt(8)
v_mfma_f32_32x32x16_bf16 v[88:103], v[64:67], v[40:43], v[88:103]
ds_read_b64_tr_b16 v[84:85], v8 offset:5120
ds_read_b64_tr_b16 v[86:87], v8 offset:7680
s_waitcnt lgkmcnt(8)
v_mfma_f32_32x32x16_bf16 v[104:119], v[68:71], v[40:43], v[104:119]
ds_read_b64_tr_b16 v[64:65], v8 offset:5184
ds_read_b64_tr_b16 v[66:67], v8 offset:7744
s_waitcnt lgkmcnt(8)
v_mfma_f32_32x32x16_bf16 v[120:135], v[72:75], v[40:43], v[120:135]
ds_read_b64_tr_b16 v[68:69], v8 offset:5248
ds_read_b64_tr_b16 v[70:71], v8 offset:7808
s_waitcnt lgkmcnt(8)
v_mfma_f32_32x32x16_bf16 v[136:151], v[76:79], v[40:43], v[136:151]
ds_read_b64_tr_b16 v[72:73], v8 offset:5312
ds_read_b64_tr_b16 v[74:75], v8 offset:7872
s_waitcnt lgkmcnt(8)
v_mfma_f32_32x32x16_bf16 v[152:167], v[80:83], v[40:43], v[152:167]
ds_read_b64_tr_b16 v[76:77], v8 offset:5376
ds_read_b64_tr_b16 v[78:79], v8 offset:7936
s_waitcnt vmcnt(4)
s_waitcnt lgkmcnt(8)
v_mfma_f32_32x32x16_bf16 v[88:103], v[84:87], v[44:47], v[88:103]
ds_read_b64_tr_b16 v[80:81], v8 offset:10240
ds_read_b64_tr_b16 v[82:83], v8 offset:12800
s_waitcnt lgkmcnt(8)
v_mfma_f32_32x32x16_bf16 v[104:119], v[64:67], v[44:47], v[104:119]
ds_read_b64_tr_b16 v[84:85], v8 offset:10304
ds_read_b64_tr_b16 v[86:87], v8 offset:12864
s_waitcnt lgkmcnt(8)
v_mfma_f32_32x32x16_bf16 v[120:135], v[68:71], v[44:47], v[120:135]
ds_read_b64_tr_b16 v[64:65], v8 offset:10368
ds_read_b64_tr_b16 v[66:67], v8 offset:12928
s_waitcnt lgkmcnt(8)
v_mfma_f32_32x32x16_bf16 v[136:151], v[72:75], v[44:47], v[136:151]
ds_read_b64_tr_b16 v[68:69], v8 offset:10432
ds_read_b64_tr_b16 v[70:71], v8 offset:12992
s_waitcnt lgkmcnt(8)
v_mfma_f32_32x32x16_bf16 v[152:167], v[76:79], v[44:47], v[152:167]
ds_read_b64_tr_b16 v[72:73], v8 offset:10496
ds_read_b64_tr_b16 v[74:75], v8 offset:13056
s_waitcnt vmcnt(3)
s_waitcnt lgkmcnt(8)
v_mfma_f32_32x32x16_bf16 v[88:103], v[80:83], v[48:51], v[88:103]
s_waitcnt lgkmcnt(6)
v_mfma_f32_32x32x16_bf16 v[104:119], v[84:87], v[48:51], v[104:119]
s_waitcnt lgkmcnt(0)
s_barrier
ds_read_b64_tr_b16 v[76:77], v9 offset:0
ds_read_b64_tr_b16 v[78:79], v9 offset:2560
ds_read_b64_tr_b16 v[80:81], v9 offset:64
ds_read_b64_tr_b16 v[82:83], v9 offset:2624
v_mfma_f32_32x32x16_bf16 v[120:135], v[64:67], v[48:51], v[120:135]
ds_read_b64_tr_b16 v[84:85], v9 offset:128
ds_read_b64_tr_b16 v[86:87], v9 offset:2688
v_mfma_f32_32x32x16_bf16 v[136:151], v[68:71], v[48:51], v[136:151]
ds_read_b64_tr_b16 v[64:65], v9 offset:192
ds_read_b64_tr_b16 v[66:67], v9 offset:2752
v_mfma_f32_32x32x16_bf16 v[152:167], v[72:75], v[48:51], v[152:167]
ds_read_b64_tr_b16 v[68:69], v9 offset:256
ds_read_b64_tr_b16 v[70:71], v9 offset:2816
s_waitcnt vmcnt(2)
s_waitcnt lgkmcnt(8)
v_mfma_f32_32x32x16_bf16 v[88:103], v[76:79], v[52:55], v[88:103]
ds_read_b64_tr_b16 v[72:73], v9 offset:5120
ds_read_b64_tr_b16 v[74:75], v9 offset:7680
s_waitcnt lgkmcnt(8)
v_mfma_f32_32x32x16_bf16 v[104:119], v[80:83], v[52:55], v[104:119]
ds_read_b64_tr_b16 v[76:77], v9 offset:5184
ds_read_b64_tr_b16 v[78:79], v9 offset:7744
s_waitcnt lgkmcnt(8)
v_mfma_f32_32x32x16_bf16 v[120:135], v[84:87], v[52:55], v[120:135]
ds_read_b64_tr_b16 v[80:81], v9 offset:5248
ds_read_b64_tr_b16 v[82:83], v9 offset:7808
s_waitcnt lgkmcnt(8)
v_mfma_f32_32x32x16_bf16 v[136:151], v[64:67], v[52:55], v[136:151]
ds_read_b64_tr_b16 v[84:85], v9 offset:5312
ds_read_b64_tr_b16 v[86:87], v9 offset:7872
s_waitcnt lgkmcnt(8)
v_mfma_f32_32x32x16_bf16 v[152:167], v[68:71], v[52:55], v[152:167]
ds_read_b64_tr_b16 v[64:65], v9 offset:5376
ds_read_b64_tr_b16 v[66:67], v9 offset:7936
s_waitcnt vmcnt(1)
s_waitcnt lgkmcnt(8)
v_mfma_f32_32x32x16_bf16 v[88:103], v[72:75], v[56:59], v[88:103]
ds_read_b64_tr_b16 v[68:69], v9 offset:10240
ds_read_b64_tr_b16 v[70:71], v9 offset:12800
s_waitcnt lgkmcnt(8)
v_mfma_f32_32x32x16_bf16 v[104:119], v[76:79], v[56:59], v[104:119]
ds_read_b64_tr_b16 v[72:73], v9 offset:10304
ds_read_b64_tr_b16 v[74:75], v9 offset:12864
s_waitcnt lgkmcnt(8)
v_mfma_f32_32x32x16_bf16 v[120:135], v[80:83], v[56:59], v[120:135]
ds_read_b64_tr_b16 v[76:77], v9 offset:10368
ds_read_b64_tr_b16 v[78:79], v9 offset:12928
s_waitcnt lgkmcnt(8)
v_mfma_f32_32x32x16_bf16 v[136:151], v[84:87], v[56:59], v[136:151]
ds_read_b64_tr_b16 v[80:81], v9 offset:10432
ds_read_b64_tr_b16 v[82:83], v9 offset:12992
s_waitcnt lgkmcnt(8)
v_mfma_f32_32x32x16_bf16 v[152:167], v[64:67], v[56:59], v[152:167]
ds_read_b64_tr_b16 v[84:85], v9 offset:10496
ds_read_b64_tr_b16 v[86:87], v9 offset:13056
s_waitcnt vmcnt(0)
s_waitcnt lgkmcnt(8)
v_mfma_f32_32x32x16_bf16 v[88:103], v[68:71], v[60:63], v[88:103]
s_waitcnt lgkmcnt(6)
v_mfma_f32_32x32x16_bf16 v[104:119], v[72:75], v[60:63], v[104:119]
s_waitcnt lgkmcnt(0)
s_barrier
v_mfma_f32_32x32x16_bf16 v[120:135], v[76:79], v[60:63], v[120:135]
v_mfma_f32_32x32x16_bf16 v[136:151], v[80:83], v[60:63], v[136:151]
v_mfma_f32_32x32x16_bf16 v[152:167], v[84:87], v[60:63], v[152:167]
s_mul_i32 s73, s3, 10240
v_add_u32 v4, s73, v1
s_xor_b32 s73, s3, 4
s_mul_i32 s73, s73, 10240
v_add_u32 v5, s73, v1
s_cmp_eq_u32 s8, 0
s_cbranch_scc1 L_FX0_G
ds_write_b128 v4, v[88:91] offset:0
ds_write_b128 v4, v[92:95] offset:1024
ds_write_b128 v4, v[96:99] offset:2048
ds_write_b128 v4, v[100:103] offset:3072
ds_write_b128 v4, v[104:107] offset:4096
ds_write_b128 v4, v[108:111] offset:5120
ds_write_b128 v4, v[112:115] offset:6144
ds_write_b128 v4, v[116:119] offset:7168
ds_write_b128 v4, v[120:123] offset:8192
ds_write_b128 v4, v[124:127] offset:9216
s_waitcnt lgkmcnt(0)
s_barrier
ds_read_b128 v[88:91], v5 offset:0
ds_read_b128 v[92:95], v5 offset:1024
ds_read_b128 v[96:99], v5 offset:2048
ds_read_b128 v[100:103], v5 offset:3072
ds_read_b128 v[104:107], v5 offset:4096
ds_read_b128 v[108:111], v5 offset:5120
ds_read_b128 v[112:115], v5 offset:6144
ds_read_b128 v[116:119], v5 offset:7168
ds_read_b128 v[120:123], v5 offset:8192
ds_read_b128 v[124:127], v5 offset:9216
s_waitcnt lgkmcnt(0)
v_pk_add_f32 v[88:89], v[88:89], v[128:129]
v_pk_add_f32 v[90:91], v[90:91], v[130:131]
v_pk_add_f32 v[92:93], v[92:93], v[132:133]
v_pk_add_f32 v[94:95], v[94:95], v[134:135]
v_pk_add_f32 v[96:97], v[96:97], v[136:137]
v_pk_add_f32 v[98:99], v[98:99], v[138:139]
v_pk_add_f32 v[100:101], v[100:101], v[140:141]
v_pk_add_f32 v[102:103], v[102:103], v[142:143]
v_pk_add_f32 v[104:105], v[104:105], v[144:145]
v_pk_add_f32 v[106:107], v[106:107], v[146:147]
v_pk_add_f32 v[108:109], v[108:109], v[148:149]
v_pk_add_f32 v[110:111], v[110:111], v[150:151]
v_pk_add_f32 v[112:113], v[112:113], v[152:153]
v_pk_add_f32 v[114:115], v[114:115], v[154:155]
v_pk_add_f32 v[116:117], v[116:117], v[156:157]
v_pk_add_f32 v[118:119], v[118:119], v[158:159]
v_pk_add_f32 v[120:121], v[120:121], v[160:161]
v_pk_add_f32 v[122:123], v[122:123], v[162:163]
v_pk_add_f32 v[124:125], v[124:125], v[164:165]
v_pk_add_f32 v[126:127], v[126:127], v[166:167]
s_branch L_FX1_G
L_FX0_G:
s_nop 2
ds_write_b128 v4, v[128:131] offset:0
ds_write_b128 v4, v[132:135] offset:1024
ds_write_b128 v4, v[136:139] offset:2048
ds_write_b128 v4, v[140:143] offset:3072
ds_write_b128 v4, v[144:147] offset:4096
ds_write_b128 v4, v[148:151] offset:5120
ds_write_b128 v4, v[152:155] offset:6144
ds_write_b128 v4, v[156:159] offset:7168
ds_write_b128 v4, v[160:163] offset:8192
ds_write_b128 v4, v[164:167] offset:9216
s_waitcnt lgkmcnt(0)
s_barrier
ds_read_b128 v[128:131], v5 offset:0
ds_read_b128 v[132:135], v5 offset:1024
ds_read_b128 v[136:139], v5 offset:2048
ds_read_b128 v[140:143], v5 offset:3072
ds_read_b128 v[144:147], v5 offset:4096
ds_read_b128 v[148:151], v5 offset:5120
ds_read_b128 v[152:155], v5 offset:6144
ds_read_b128 v[156:159], v5 offset:7168
ds_read_b128 v[160:163], v5 offset:8192
ds_read_b128 v[164:167], v5 offset:9216
s_waitcnt lgkmcnt(0)
v_pk_add_f32 v[88:89], v[88:89], v[128:129]
v_pk_add_f32 v[90:91], v[90:91], v[130:131]
v_pk_add_f32 v[92:93], v[92:93], v[132:133]
v_pk_add_f32 v[94:95], v[94:95], v[134:135]
v_pk_add_f32 v[96:97], v[96:97], v[136:137]
v_pk_add_f32 v[98:99], v[98:99], v[138:139]
v_pk_add_f32 v[100:101], v[100:101], v[140:141]
v_pk_add_f32 v[102:103], v[102:103], v[142:143]
v_pk_add_f32 v[104:105], v[104:105], v[144:145]
v_pk_add_f32 v[106:107], v[106:107], v[146:147]
v_pk_add_f32 v[108:109], v[108:109], v[148:149]
v_pk_add_f32 v[110:111], v[110:111], v[150:151]
v_pk_add_f32 v[112:113], v[112:113], v[152:153]
v_pk_add_f32 v[114:115], v[114:115], v[154:155]
v_pk_add_f32 v[116:117], v[116:117], v[156:157]
v_pk_add_f32 v[118:119], v[118:119], v[158:159]
v_pk_add_f32 v[120:121], v[120:121], v[160:161]
v_pk_add_f32 v[122:123], v[122:123], v[162:163]
v_pk_add_f32 v[124:125], v[124:125], v[164:165]
v_pk_add_f32 v[126:127], v[126:127], v[166:167]
L_FX1_G:
s_cmp_eq_u32 s7, s81
s_cbranch_scc1 L_OWN_G
s_lshl_b32 s84, s5, 2
s_add_u32 s84, s84, s10
s_lshl_b32 s84, s84, 2
s_add_u32 s84, s84, s7
s_lshl_b32 s82, s84, 8
s_add_u32 s82, s82, 589824
s_lshl_b32 s84, s84, 2
s_add_u32 s84, s84, s81
s_mul_i32 s84, s84, 10
s_mul_i32 s85, s8, 5
s_add_u32 s84, s84, s85
s_lshl_b32 s84, s84, 10
s_add_u32 s84, s84, 16777216
v_cvt_pk_bf16_f32 v128, v88, v89
v_cvt_pk_bf16_f32 v129, v90, v91
v_cvt_pk_bf16_f32 v130, v92, v93
v_cvt_pk_bf16_f32 v131, v94, v95
v_cvt_pk_bf16_f32 v132, v96, v97
v_cvt_pk_bf16_f32 v133, v98, v99
v_cvt_pk_bf16_f32 v134, v100, v101
v_cvt_pk_bf16_f32 v135, v102, v103
v_cvt_pk_bf16_f32 v136, v104, v105
v_cvt_pk_bf16_f32 v137, v106, v107
v_cvt_pk_bf16_f32 v138, v108, v109
v_cvt_pk_bf16_f32 v139, v110, v111
v_cvt_pk_bf16_f32 v140, v112, v113
v_cvt_pk_bf16_f32 v141, v114, v115
v_cvt_pk_bf16_f32 v142, v116, v117
v_cvt_pk_bf16_f32 v143, v118, v119
v_cvt_pk_bf16_f32 v144, v120, v121
v_cvt_pk_bf16_f32 v145, v122, v123
v_cvt_pk_bf16_f32 v146, v124, v125
v_cvt_pk_bf16_f32 v147, v126, v127
s_lshr_b32 s83, s7, 1
s_cmp_eq_u32 s83, 1
s_cselect_b32 s83, s96, 0
s_lshr_b32 s85, s7, 1
s_cmp_eq_u32 s85, 1
s_cbranch_scc1 L_FA_G
s_lshl_b32 s85, s9, 3
s_add_u32 s82, s82, s85
s_add_u32 s82, s82, 128
L_FA_G:
s_lshl_b32 s85, s8, 2
s_add_u32 s82, s82, s85
s_cmp_eq_u32 s83, 1
s_cbranch_scc1 L_SNDL_G
buffer_store_dwordx4 v[128:131], v1, s[12:15], s84 offen offset:0 sc1
buffer_store_dwordx4 v[132:135], v1, s[12:15], s84 offen offset:1024 sc1
buffer_store_dwordx4 v[136:139], v1, s[12:15], s84 offen offset:2048 sc1
buffer_store_dwordx4 v[140:143], v1, s[12:15], s84 offen offset:3072 sc1
s_add_u32 s84, s84, 4096
buffer_store_dwordx4 v[144:147], v1, s[12:15], s84 offen offset:0 sc1
s_branch L_SENT_G
L_SNDL_G:
buffer_store_dwordx4 v[128:131], v1, s[12:15], s84 offen offset:0 sc1
buffer_store_dwordx4 v[132:135], v1, s[12:15], s84 offen offset:1024 sc1
buffer_store_dwordx4 v[136:139], v1, s[12:15], s84 offen offset:2048 sc1
buffer_store_dwordx4 v[140:143], v1, s[12:15], s84 offen offset:3072 sc1
s_add_u32 s84, s84, 4096
buffer_store_dwordx4 v[144:147], v1, s[12:15], s84 offen offset:0 sc1
s_branch L_SENT_G
L_OWN_G:
s_mul_i32 s84, s8, 10240
s_add_u32 s84, s84, 81920
v_add_u32 v4, s84, v1
ds_write_b128 v4, v[88:91] offset:0
ds_write_b128 v4, v[92:95] offset:1024
ds_write_b128 v4, v[96:99] offset:2048
ds_write_b128 v4, v[100:103] offset:3072
ds_write_b128 v4, v[104:107] offset:4096
ds_write_b128 v4, v[108:111] offset:5120
ds_write_b128 v4, v[112:115] offset:6144
ds_write_b128 v4, v[116:119] offset:7168
ds_write_b128 v4, v[120:123] offset:8192
ds_write_b128 v4, v[124:127] offset:9216
L_SENT_G:
s_waitcnt lgkmcnt(0)
s_barrier
s_cmp_eq_u32 s7, s81
s_cbranch_scc1 L_NOFLAG_G
s_waitcnt vmcnt(0)
v_mov_b32 v12, s11
s_mov_b64 exec, 1
s_cmp_eq_u32 s83, 1
s_cbranch_scc1 L_FLL_G
buffer_store_dword v12, off, s[12:15], s82 sc1
s_branch L_FLD_G
L_FLL_G:
buffer_store_dword v12, off, s[12:15], s82
L_FLD_G:
s_mov_b64 exec, -1
L_NOFLAG_G:
s_lshl_b32 s84, s5, 2
s_add_u32 s84, s84, s10
s_lshl_b32 s84, s84, 2
s_add_u32 s84, s84, s81
s_lshl_b32 s82, s84, 8
s_add_u32 s82, s82, 589824
s_mul_i32 s84, s84, 40960
s_add_u32 s84, s84, 16777216
s_lshl_b32 s83, s3, 10
s_add_u32 s84, s84, s83
s_xor_b32 s85, s81, 1
s_mul_i32 s85, s85, 10240
s_add_u32 s85, s85, s84
s_add_u32 s86, s84, 0
s_lshl_b32 s83, s3, 11
s_add_u32 s83, s83, 81920
v_add_u32 v5, s83, v1
v_add_u32 v4, 162560, v3
v_add_u32 v7, s90, v4
ds_read_b128 v[128:131], v5 offset:0
ds_read_b64 v[112:113], v7 offset:0
ds_read_b64 v[114:115], v7 offset:320
ds_read_b128 v[132:135], v5 offset:1024
ds_read_b64 v[116:117], v7 offset:16
ds_read_b64 v[118:119], v7 offset:336
s_cmp_ge_u32 s3, 2
s_cbranch_scc1 L_FR_G
v_add_u32 v5, 16384, v5
v_add_u32 v7, s91, v4
ds_read_b128 v[136:139], v5 offset:0
ds_read_b64 v[120:121], v7 offset:0
ds_read_b64 v[122:123], v7 offset:320
ds_read_b128 v[140:143], v5 offset:1024
ds_read_b64 v[124:125], v7 offset:16
ds_read_b64 v[126:127], v7 offset:336
L_FR_G:
v_and_b32 v4, 31, v0
s_lshl_b32 s83, s81, 5
v_add_u32 v4, s83, v4
v_lshlrev_b32 v4, 3, v4
v_add_u32 v4, 158976, v4
ds_read_b64 v[10:11], v4
s_mov_b32 s32, s64
s_mov_b32 s33, s65
s_mov_b32 s34, 5242880
s_mov_b32 s35, 0x20000
s_mov_b32 s94, 0x00003f80
s_mov_b32 s95, 0x3f800000
v_and_b32 v3, 16, v0
v_sub_u32 v6, v2, v3
v_mul_u32_u24 v6, 2560, v6
v_lshl_add_u32 v6, v3, 1, v6
v_lshrrev_b32 v3, 5, v0
v_lshl_add_u32 v6, v3, 4, v6
v_min_u32 v12, 5, v0
v_lshlrev_b32 v13, 2, v12
v_add_u32 v14, 120, v13
v_cmp_gt_u32 vcc, 2, v12
s_nop 1
v_cndmask_b32 v13, v14, v13, vcc
s_mov_b32 s80, 65536
L_CP_G:
buffer_load_dword v14, v13, s[12:15], s82 offen sc1
s_waitcnt vmcnt(0)
v_cmp_ne_u32 vcc, s11, v14
s_cbranch_vccz L_FP_G
s_sleep 4
s_sub_u32 s80, s80, 1
s_cmp_lg_u32 s80, 0
s_cbranch_scc1 L_CP_G
L_FP_G:
buffer_load_dwordx4 v[88:91], v1, s[12:15], s85 offen
buffer_load_dwordx4 v[92:95], v1, s[12:15], s86 offen
s_add_u32 s83, s86, 10240
buffer_load_dwordx4 v[96:99], v1, s[12:15], s83 offen
s_cmp_ge_u32 s3, 2
s_cbranch_scc1 L_FI_G
s_add_u32 s85, s85, 8192
s_add_u32 s86, s86, 8192
buffer_load_dwordx4 v[100:103], v1, s[12:15], s85 offen
buffer_load_dwordx4 v[104:107], v1, s[12:15], s86 offen
s_add_u32 s83, s86, 10240
buffer_load_dwordx4 v[108:111], v1, s[12:15], s83 offen
L_FI_G:
s_waitcnt lgkmcnt(0)
v_mul_f32 v12, v10, v11
v_sub_f32 v12, 0, v12
v_mul_f32 v13, v11, v11
s_cmp_lt_u32 s3, 2
s_cbranch_scc1 L_F2_G
s_waitcnt vmcnt(0)
s_branch L_F3_G
L_F2_G:
s_waitcnt vmcnt(3)
L_F3_G:
v_dot2_f32_bf16 v128, v88, s94, v128
v_dot2_f32_bf16 v129, v88, s95, v129
v_dot2_f32_bf16 v130, v89, s94, v130
v_dot2_f32_bf16 v131, v89, s95, v131
v_dot2_f32_bf16 v40, v92, s94, 0
v_dot2_f32_bf16 v41, v92, s95, 0
v_dot2_f32_bf16 v42, v93, s94, 0
v_dot2_f32_bf16 v43, v93, s95, 0
v_dot2_f32_bf16 v40, v96, s94, v40
v_dot2_f32_bf16 v41, v96, s95, v41
v_dot2_f32_bf16 v42, v97, s94, v42
v_dot2_f32_bf16 v43, v97, s95, v43
v_lshlrev_b32 v44, 16, v16
v_and_b32 v45, 0xffff0000, v16
v_lshlrev_b32 v46, 16, v17
v_and_b32 v47, 0xffff0000, v17
v_lshlrev_b32 v48, 16, v112
v_and_b32 v49, 0xffff0000, v112
v_lshlrev_b32 v50, 16, v113
v_and_b32 v51, 0xffff0000, v113
v_lshlrev_b32 v52, 16, v114
v_and_b32 v53, 0xffff0000, v114
v_lshlrev_b32 v54, 16, v115
v_and_b32 v55, 0xffff0000, v115
v_fma_f32 v56, v44, v11, v12
v_fma_f32 v57, v45, v11, v12
v_fma_f32 v58, v46, v11, v12
v_fma_f32 v59, v47, v11, v12
v_fmac_f32 v40, v56, v48
v_fmac_f32 v41, v57, v49
v_fmac_f32 v42, v58, v50
v_fmac_f32 v43, v59, v51
v_fma_f32 v128, v128, v13, v52
v_fma_f32 v129, v129, v13, v53
v_fma_f32 v130, v130, v13, v54
v_fma_f32 v131, v131, v13, v55
v_mul_f32 v56, 0xbfb8aa3b, v128
v_mul_f32 v57, 0xbfb8aa3b, v129
v_mul_f32 v58, 0xbfb8aa3b, v130
v_mul_f32 v59, 0xbfb8aa3b, v131
v_exp_f32 v56, v56
v_exp_f32 v57, v57
v_exp_f32 v58, v58
v_exp_f32 v59, v59
v_add_f32 v56, 1.0, v56
v_add_f32 v57, 1.0, v57
v_add_f32 v58, 1.0, v58
v_add_f32 v59, 1.0, v59
v_rcp_f32 v56, v56
v_rcp_f32 v57, v57
v_rcp_f32 v58, v58
v_rcp_f32 v59, v59
v_mul_f32 v128, v128, v56
v_mul_f32 v129, v129, v57
v_mul_f32 v130, v130, v58
v_mul_f32 v131, v131, v59
v_fma_f32 v60, v40, v128, v44
v_fma_f32 v61, v41, v129, v45
v_fma_f32 v62, v42, v130, v46
v_fma_f32 v63, v43, v131, v47
s_add_u32 s83, s92, s90
s_lshl_b32 s83, s83, 1
v_dot2_f32_bf16 v132, v90, s94, v132
v_dot2_f32_bf16 v133, v90, s95, v133
v_dot2_f32_bf16 v134, v91, s94, v134
v_dot2_f32_bf16 v135, v91, s95, v135
v_dot2_f32_bf16 v40, v94, s94, 0
v_dot2_f32_bf16 v41, v94, s95, 0
v_dot2_f32_bf16 v42, v95, s94, 0
v_dot2_f32_bf16 v43, v95, s95, 0
v_dot2_f32_bf16 v40, v98, s94, v40
v_dot2_f32_bf16 v41, v98, s95, v41
v_dot2_f32_bf16 v42, v99, s94, v42
v_dot2_f32_bf16 v43, v99, s95, v43
v_lshlrev_b32 v44, 16, v18
v_and_b32 v45, 0xffff0000, v18
v_lshlrev_b32 v46, 16, v19
v_and_b32 v47, 0xffff0000, v19
v_lshlrev_b32 v48, 16, v116
v_and_b32 v49, 0xffff0000, v116
v_lshlrev_b32 v50, 16, v117
v_and_b32 v51, 0xffff0000, v117
v_lshlrev_b32 v52, 16, v118
v_and_b32 v53, 0xffff0000, v118
v_lshlrev_b32 v54, 16, v119
v_and_b32 v55, 0xffff0000, v119
v_fma_f32 v56, v44, v11, v12
v_fma_f32 v57, v45, v11, v12
v_fma_f32 v58, v46, v11, v12
v_fma_f32 v59, v47, v11, v12
v_fmac_f32 v40, v56, v48
v_fmac_f32 v41, v57, v49
v_fmac_f32 v42, v58, v50
v_fmac_f32 v43, v59, v51
v_fma_f32 v132, v132, v13, v52
v_fma_f32 v133, v133, v13, v53
v_fma_f32 v134, v134, v13, v54
v_fma_f32 v135, v135, v13, v55
v_mul_f32 v56, 0xbfb8aa3b, v132
v_mul_f32 v57, 0xbfb8aa3b, v133
v_mul_f32 v58, 0xbfb8aa3b, v134
v_mul_f32 v59, 0xbfb8aa3b, v135
v_exp_f32 v56, v56
v_exp_f32 v57, v57
v_exp_f32 v58, v58
v_exp_f32 v59, v59
v_add_f32 v56, 1.0, v56
v_add_f32 v57, 1.0, v57
v_add_f32 v58, 1.0, v58
v_add_f32 v59, 1.0, v59
v_rcp_f32 v56, v56
v_rcp_f32 v57, v57
v_rcp_f32 v58, v58
v_rcp_f32 v59, v59
v_mul_f32 v132, v132, v56
v_mul_f32 v133, v133, v57
v_mul_f32 v134, v134, v58
v_mul_f32 v135, v135, v59
v_fma_f32 v64, v40, v132, v44
v_fma_f32 v65, v41, v133, v45
v_fma_f32 v66, v42, v134, v46
v_fma_f32 v67, v43, v135, v47
s_add_u32 s82, s83, 40960
s_nop 1
v_permlane16_swap_b32 v60, v64
v_permlane16_swap_b32 v61, v65
v_permlane16_swap_b32 v62, v66
v_permlane16_swap_b32 v63, v67
buffer_store_dwordx4 v[60:63], v6, s[32:35], s83 offen nt
buffer_store_dwordx4 v[64:67], v6, s[32:35], s82 offen nt
s_cmp_ge_u32 s3, 2
s_cbranch_scc1 L_FE_G
s_waitcnt vmcnt(2)
v_dot2_f32_bf16 v136, v100, s94, v136
v_dot2_f32_bf16 v137, v100, s95, v137
v_dot2_f32_bf16 v138, v101, s94, v138
v_dot2_f32_bf16 v139, v101, s95, v139
v_dot2_f32_bf16 v40, v104, s94, 0
v_dot2_f32_bf16 v41, v104, s95, 0
v_dot2_f32_bf16 v42, v105, s94, 0
v_dot2_f32_bf16 v43, v105, s95, 0
v_dot2_f32_bf16 v40, v108, s94, v40
v_dot2_f32_bf16 v41, v108, s95, v41
v_dot2_f32_bf16 v42, v109, s94, v42
v_dot2_f32_bf16 v43, v109, s95, v43
v_lshlrev_b32 v44, 16, v20
v_and_b32 v45, 0xffff0000, v20
v_lshlrev_b32 v46, 16, v21
v_and_b32 v47, 0xffff0000, v21
v_lshlrev_b32 v48, 16, v120
v_and_b32 v49, 0xffff0000, v120
v_lshlrev_b32 v50, 16, v121
v_and_b32 v51, 0xffff0000, v121
v_lshlrev_b32 v52, 16, v122
v_and_b32 v53, 0xffff0000, v122
v_lshlrev_b32 v54, 16, v123
v_and_b32 v55, 0xffff0000, v123
v_fma_f32 v56, v44, v11, v12
v_fma_f32 v57, v45, v11, v12
v_fma_f32 v58, v46, v11, v12
v_fma_f32 v59, v47, v11, v12
v_fmac_f32 v40, v56, v48
v_fmac_f32 v41, v57, v49
v_fmac_f32 v42, v58, v50
v_fmac_f32 v43, v59, v51
v_fma_f32 v136, v136, v13, v52
v_fma_f32 v137, v137, v13, v53
v_fma_f32 v138, v138, v13, v54
v_fma_f32 v139, v139, v13, v55
v_mul_f32 v56, 0xbfb8aa3b, v136
v_mul_f32 v57, 0xbfb8aa3b, v137
v_mul_f32 v58, 0xbfb8aa3b, v138
v_mul_f32 v59, 0xbfb8aa3b, v139
v_exp_f32 v56, v56
v_exp_f32 v57, v57
v_exp_f32 v58, v58
v_exp_f32 v59, v59
v_add_f32 v56, 1.0, v56
v_add_f32 v57, 1.0, v57
v_add_f32 v58, 1.0, v58
v_add_f32 v59, 1.0, v59
v_rcp_f32 v56, v56
v_rcp_f32 v57, v57
v_rcp_f32 v58, v58
v_rcp_f32 v59, v59
v_mul_f32 v136, v136, v56
v_mul_f32 v137, v137, v57
v_mul_f32 v138, v138, v58
v_mul_f32 v139, v139, v59
v_fma_f32 v60, v40, v136, v44
v_fma_f32 v61, v41, v137, v45
v_fma_f32 v62, v42, v138, v46
v_fma_f32 v63, v43, v139, v47
s_add_u32 s83, s92, s91
s_lshl_b32 s83, s83, 1
v_dot2_f32_bf16 v140, v102, s94, v140
v_dot2_f32_bf16 v141, v102, s95, v141
v_dot2_f32_bf16 v142, v103, s94, v142
v_dot2_f32_bf16 v143, v103, s95, v143
v_dot2_f32_bf16 v40, v106, s94, 0
v_dot2_f32_bf16 v41, v106, s95, 0
v_dot2_f32_bf16 v42, v107, s94, 0
v_dot2_f32_bf16 v43, v107, s95, 0
v_dot2_f32_bf16 v40, v110, s94, v40
v_dot2_f32_bf16 v41, v110, s95, v41
v_dot2_f32_bf16 v42, v111, s94, v42
v_dot2_f32_bf16 v43, v111, s95, v43
v_lshlrev_b32 v44, 16, v22
v_and_b32 v45, 0xffff0000, v22
v_lshlrev_b32 v46, 16, v23
v_and_b32 v47, 0xffff0000, v23
v_lshlrev_b32 v48, 16, v124
v_and_b32 v49, 0xffff0000, v124
v_lshlrev_b32 v50, 16, v125
v_and_b32 v51, 0xffff0000, v125
v_lshlrev_b32 v52, 16, v126
v_and_b32 v53, 0xffff0000, v126
v_lshlrev_b32 v54, 16, v127
v_and_b32 v55, 0xffff0000, v127
v_fma_f32 v56, v44, v11, v12
v_fma_f32 v57, v45, v11, v12
v_fma_f32 v58, v46, v11, v12
v_fma_f32 v59, v47, v11, v12
v_fmac_f32 v40, v56, v48
v_fmac_f32 v41, v57, v49
v_fmac_f32 v42, v58, v50
v_fmac_f32 v43, v59, v51
v_fma_f32 v140, v140, v13, v52
v_fma_f32 v141, v141, v13, v53
v_fma_f32 v142, v142, v13, v54
v_fma_f32 v143, v143, v13, v55
v_mul_f32 v56, 0xbfb8aa3b, v140
v_mul_f32 v57, 0xbfb8aa3b, v141
v_mul_f32 v58, 0xbfb8aa3b, v142
v_mul_f32 v59, 0xbfb8aa3b, v143
v_exp_f32 v56, v56
v_exp_f32 v57, v57
v_exp_f32 v58, v58
v_exp_f32 v59, v59
v_add_f32 v56, 1.0, v56
v_add_f32 v57, 1.0, v57
v_add_f32 v58, 1.0, v58
v_add_f32 v59, 1.0, v59
v_rcp_f32 v56, v56
v_rcp_f32 v57, v57
v_rcp_f32 v58, v58
v_rcp_f32 v59, v59
v_mul_f32 v140, v140, v56
v_mul_f32 v141, v141, v57
v_mul_f32 v142, v142, v58
v_mul_f32 v143, v143, v59
v_fma_f32 v64, v40, v140, v44
v_fma_f32 v65, v41, v141, v45
v_fma_f32 v66, v42, v142, v46
v_fma_f32 v67, v43, v143, v47
s_add_u32 s82, s83, 40960
s_nop 1
v_permlane16_swap_b32 v60, v64
v_permlane16_swap_b32 v61, v65
v_permlane16_swap_b32 v62, v66
v_permlane16_swap_b32 v63, v67
buffer_store_dwordx4 v[60:63], v6, s[32:35], s83 offen nt
buffer_store_dwordx4 v[64:67], v6, s[32:35], s82 offen nt
L_FE_G:
s_endpgm
L_LOADER:
s_cmp_eq_u32 s4, 1
s_cbranch_scc1 L_LOADER_G
L_LOADER_S:
buffer_load_dword v40, off, s[12:15], 0 sc1
s_cmp_lg_u32 s7, 3
s_cbranch_scc1 L_LDS_e0
v_lshlrev_b32 v13, 4, v0
s_mul_i32 s73, s10, 320
s_mov_b32 exec_lo, 0xfffff
s_mov_b32 exec_hi, 0
s_mov_b32 s28, s52
s_mov_b32 s29, s53
s_mov_b32 s30, 1280
s_mov_b32 s31, 0x20000
s_mov_b32 m0, 162560
s_nop 0
buffer_load_dwordx4 v13, s[28:31], s73 offen lds
s_mov_b32 s28, s62
s_mov_b32 s29, s63
s_mov_b32 s30, 1280
s_mov_b32 s31, 0x20000
s_mov_b32 m0, 162880
s_nop 0
buffer_load_dwordx4 v13, s[28:31], s73 offen lds
s_mov_b64 exec, -1
s_branch L_LDS_e1
L_LDS_e0:
s_lshl_b32 s73, s7, 6
v_add_u32 v42, s73, v0
v_min_u32 v42, 159, v42
v_lshrrev_b32 v13, 5, v42
v_and_b32 v14, 31, v42
v_lshrrev_b32 v14, 1, v14
v_lshl_add_u32 v13, v13, 4, v14
s_mul_i32 s73, s6, 80
v_add_u32 v13, s73, v13
v_lshlrev_b32 v13, 1, v13
global_load_ushort v44, v13, s[38:39]
global_load_ushort v45, v13, s[40:41]
global_load_ushort v46, v13, s[50:51]
L_LDS_e1:
s_and_b32 s73, s7, 1
s_lshl_b32 s73, s73, 2
v_lshrrev_b32 v2, 4, v0
v_add_u32 v2, s73, v2
v_and_b32 v2, 7, v2
v_and_b32 v3, 7, v0
v_xor_b32 v2, v2, v3
v_lshlrev_b32 v2, 4, v2
v_lshrrev_b32 v3, 3, v0
v_mul_u32_u24 v3, 1280, v3
v_add_u32 v1, v2, v3
s_lshl_b32 s71, s5, 7
s_lshl_b32 s73, s7, 3
s_add_u32 s71, s71, s73
s_mul_i32 s71, s71, 1280
s_and_b32 s76, s5, 3
s_mul_i32 s76, s76, 1
s_add_u32 s76, s76, s6
s_cmp_ge_u32 s76, 10
s_cselect_b32 s73, 10, 0
s_sub_u32 s76, s76, s73
s_lshl_b32 s73, s76, 7
s_add_u32 s71, s71, s73
s_and_b32 s73, s7, 1
s_cmp_eq_u32 s73, 1
s_cselect_b64 s[20:21], s[44:45], s[42:43]
s_mov_b32 s22, 819200
s_mov_b32 s23, 0x20000
s_mul_i32 s72, s6, 80
s_lshr_b32 s73, s7, 1
s_lshl_b32 s73, s73, 3
s_add_u32 s72, s72, s73
s_mul_i32 s72, s72, 1280
s_mul_i32 s73, s76, 128
s_add_u32 s72, s72, s73
s_mov_b32 s70, 81920
s_lshl_b32 s73, s7, 10
s_add_u32 m0, s70, s73
s_mov_b32 s75, s71
buffer_load_dwordx4 v1, s[16:19], s75 offen lds
s_add_u32 m0, m0, 4096
s_add_u32 s75, s75, 40960
buffer_load_dwordx4 v1, s[16:19], s75 offen lds
s_add_u32 m0, m0, 4096
s_add_u32 s75, s75, 40960
buffer_load_dwordx4 v1, s[16:19], s75 offen lds
s_add_u32 m0, m0, 4096
s_add_u32 s75, s75, 40960
buffer_load_dwordx4 v1, s[16:19], s75 offen lds
s_lshl_b32 s73, s7, 10
s_add_u32 s73, s73, 16384
s_add_u32 m0, s70, s73
s_mov_b32 s75, s72
buffer_load_dwordx4 v1, s[20:23], s75 offen lds
s_add_u32 m0, m0, 4096
s_add_u32 s75, s75, 20480
buffer_load_dwordx4 v1, s[20:23], s75 offen lds
s_add_u32 m0, m0, 4096
s_add_u32 s75, s75, 20480
buffer_load_dwordx4 v1, s[20:23], s75 offen lds
s_add_u32 m0, m0, 4096
s_add_u32 s75, s75, 20480
buffer_load_dwordx4 v1, s[20:23], s75 offen lds
s_add_u32 m0, m0, 4096
s_add_u32 s75, s75, 20480
buffer_load_dwordx4 v1, s[20:23], s75 offen lds
s_add_u32 s72, s72, 128
s_add_u32 s71, s71, 128
s_add_u32 s70, s70, 40960
s_cmp_eq_u32 s70, 122880
s_cselect_b32 s70, 0, s70
s_add_u32 s76, s76, 1
s_cmp_lg_u32 s76, 10
s_cbranch_scc1 L_WRAP_18
s_sub_u32 s71, s71, 1280
s_sub_u32 s72, s72, 1280
s_mov_b32 s76, 0
L_WRAP_18:
v_lshlrev_b32 v5, 4, v0
v_mov_b32 v16, 0
v_mov_b32 v17, 0
v_mov_b32 v18, 0
v_mov_b32 v19, 0
v_mov_b32 v13, 155648
ds_write_b128 v13, v[16:19]
s_cmp_eq_u32 s7, 3
s_cbranch_scc1 L_LDS_ga3
s_lshl_b32 s73, s7, 6
v_add_u32 v42, s73, v0
v_min_u32 v42, 159, v42
v_and_b32 v13, 1, v42
v_mul_u32_u24 v13, 640, v13
v_lshrrev_b32 v14, 5, v42
v_lshl_add_u32 v13, v14, 4, v13
v_and_b32 v14, 31, v42
v_lshrrev_b32 v14, 1, v14
v_add_u32 v13, v13, v14
s_mul_i32 s73, s6, 80
v_add_u32 v13, s73, v13
v_lshlrev_b32 v41, 3, v13
s_mov_b32 s78, 40960
v_mov_b32 v43, 0
s_branch L_LDS_ga4
L_LDS_ga3:
v_lshlrev_b32 v41, 4, v0
s_lshl_b32 s78, s5, 11
s_add_u32 s78, s78, 8192
v_mov_b32 v42, v0
s_lshr_b32 s73, s2, 3
s_and_b32 s73, s73, 24
s_lshl_b32 s73, s73, 3
s_and_b32 s75, s2, 7
s_add_u32 s73, s73, s75
v_and_b32 v43, 7, v0
v_lshl_add_u32 v43, v43, 3, s73
v_lshlrev_b32 v43, 3, v43
v_add_u32 v43, 57344, v43
L_LDS_ga4:
s_mov_b32 s74, 0
L_LDS_LOOP:
s_waitcnt vmcnt(9) lgkmcnt(0)
s_cmp_lg_u32 s74, 0
s_cbranch_scc1 L_LDS_n0
s_waitcnt vmcnt(0)
v_readfirstlane_b32 s11, v40
s_mul_i32 s11, s11, 1664525
s_add_u32 s11, s11, 1013904223
L_LDS_n0:
s_barrier
s_cmp_eq_u32 s74, 7
s_cbranch_scc1 L_LDS_tail
s_cmp_lg_u32 s74, 0
s_cbranch_scc1 L_LDS_e1x
s_lshl_b32 s73, s7, 10
s_add_u32 m0, s70, s73
s_mov_b32 s75, s71
buffer_load_dwordx4 v1, s[16:19], s75 offen lds
s_add_u32 m0, m0, 4096
s_add_u32 s75, s75, 40960
buffer_load_dwordx4 v1, s[16:19], s75 offen lds
s_add_u32 m0, m0, 4096
s_add_u32 s75, s75, 40960
buffer_load_dwordx4 v1, s[16:19], s75 offen lds
s_add_u32 m0, m0, 4096
s_add_u32 s75, s75, 40960
buffer_load_dwordx4 v1, s[16:19], s75 offen lds
s_lshl_b32 s73, s7, 10
s_add_u32 s73, s73, 16384
s_add_u32 m0, s70, s73
s_mov_b32 s75, s72
buffer_load_dwordx4 v1, s[20:23], s75 offen lds
s_add_u32 m0, m0, 4096
s_add_u32 s75, s75, 20480
buffer_load_dwordx4 v1, s[20:23], s75 offen lds
s_add_u32 m0, m0, 4096
s_add_u32 s75, s75, 20480
buffer_load_dwordx4 v1, s[20:23], s75 offen lds
s_add_u32 m0, m0, 4096
s_add_u32 s75, s75, 20480
buffer_load_dwordx4 v1, s[20:23], s75 offen lds
s_add_u32 m0, m0, 4096
s_add_u32 s75, s75, 20480
buffer_load_dwordx4 v1, s[20:23], s75 offen lds
s_add_u32 s72, s72, 128
s_add_u32 s71, s71, 128
s_add_u32 s70, s70, 40960
s_cmp_eq_u32 s70, 122880
s_cselect_b32 s70, 0, s70
s_add_u32 s76, s76, 1
s_cmp_lg_u32 s76, 10
s_cbranch_scc1 L_WRAP_19
s_sub_u32 s71, s71, 1280
s_sub_u32 s72, s72, 1280
s_mov_b32 s76, 0
L_WRAP_19:
L_LDS_e1x:
s_lshl_b32 s73, s7, 10
s_add_u32 m0, s70, s73
s_mov_b32 s75, s71
buffer_load_dwordx4 v1, s[16:19], s75 offen lds
s_add_u32 m0, m0, 4096
s_add_u32 s75, s75, 40960
buffer_load_dwordx4 v1, s[16:19], s75 offen lds
s_add_u32 m0, m0, 4096
s_add_u32 s75, s75, 40960
buffer_load_dwordx4 v1, s[16:19], s75 offen lds
s_add_u32 m0, m0, 4096
s_add_u32 s75, s75, 40960
buffer_load_dwordx4 v1, s[16:19], s75 offen lds
s_lshl_b32 s73, s7, 10
s_add_u32 s73, s73, 16384
s_add_u32 m0, s70, s73
s_mov_b32 s75, s72
buffer_load_dwordx4 v1, s[20:23], s75 offen lds
s_add_u32 m0, m0, 4096
s_add_u32 s75, s75, 20480
buffer_load_dwordx4 v1, s[20:23], s75 offen lds
s_add_u32 m0, m0, 4096
s_add_u32 s75, s75, 20480
buffer_load_dwordx4 v1, s[20:23], s75 offen lds
s_add_u32 m0, m0, 4096
s_add_u32 s75, s75, 20480
buffer_load_dwordx4 v1, s[20:23], s75 offen lds
s_add_u32 m0, m0, 4096
s_add_u32 s75, s75, 20480
buffer_load_dwordx4 v1, s[20:23], s75 offen lds
s_add_u32 s72, s72, 128
s_add_u32 s71, s71, 128
s_add_u32 s70, s70, 40960
s_cmp_eq_u32 s70, 122880
s_cselect_b32 s70, 0, s70
s_add_u32 s76, s76, 1
s_cmp_lg_u32 s76, 10
s_cbranch_scc1 L_WRAP_20
s_sub_u32 s71, s71, 1280
s_sub_u32 s72, s72, 1280
s_mov_b32 s76, 0
L_WRAP_20:
s_cmp_lg_u32 s74, 0
s_cbranch_scc1 L_LDS_nl
s_cmp_eq_u32 s7, 3
s_cbranch_scc1 L_LDS_nl
v_and_b32 v82, 1, v42
v_lshlrev_b32 v82, 31, v82
v_or_b32 v82, 0x3f800000, v82
v_lshlrev_b32 v44, 16, v44
v_lshlrev_b32 v45, 16, v45
v_lshlrev_b32 v46, 16, v46
v_mul_f32 v46, 0x3fb8aa3b, v46
v_exp_f32 v46, v46
s_nop 0
v_cvt_pk_bf16_f32 v46, v46, v46
v_lshlrev_b32 v46, 16, v46
v_mul_f32 v52, v46, v44
v_mul_f32 v53, v46, v45
v_mul_f32 v52, 0x3fb8aa3b, v52
v_exp_f32 v52, v52
v_mul_f32 v53, 0.15915494, v53
v_rndne_f32 v54, v53
v_sub_f32 v53, v53, v54
v_cos_f32 v54, v53
v_sin_f32 v55, v53
v_mul_f32 v48, v52, v54
v_mul_f32 v55, v52, v55
v_add_f32 v54, -1.0, v48
v_mul_f32 v56, v44, v44
v_fmac_f32 v56, v45, v45
v_rcp_f32 v56, v56
v_mul_f32 v52, v54, v44
v_fmac_f32 v52, v55, v45
v_mul_f32 v53, v55, v44
v_fma_f32 v53, -v54, v45, v53
v_add_f32 v56, v56, v56
v_mul_f32 v52, v52, v56
v_mul_f32 v53, v53, v56
v_mul_f32 v50, v52, v82
v_sub_f32 v51, 0, v53
v_mul_f32 v49, v55, v82
v_lshlrev_b32 v13, 4, v42
v_add_u32 v13, 160000, v13
ds_write_b128 v13, v[48:51]
v_mov_b32 v80, v48
v_mov_b32 v81, v55
v_mul_f32 v54, v81, v81
v_mul_f32 v56, v80, v81
v_fma_f32 v80, v80, v80, -v54
v_add_f32 v81, v56, v56
v_mul_f32 v54, v81, v81
v_mul_f32 v56, v80, v81
v_fma_f32 v80, v80, v80, -v54
v_add_f32 v81, v56, v56
v_mul_f32 v54, v81, v81
v_mul_f32 v56, v80, v81
v_fma_f32 v80, v80, v80, -v54
v_add_f32 v81, v56, v56
v_mul_f32 v54, v81, v81
v_mul_f32 v56, v80, v81
v_fma_f32 v80, v80, v80, -v54
v_add_f32 v81, v56, v56
L_LDS_nl:
s_add_u32 s74, s74, 1
s_branch L_LDS_LOOP
L_LDS_tail:
s_lshl_b32 s73, s7, 10
s_add_u32 m0, s70, s73
s_mov_b32 s75, s71
buffer_load_dwordx4 v1, s[16:19], s75 offen lds
s_add_u32 m0, m0, 4096
s_add_u32 s75, s75, 40960
buffer_load_dwordx4 v1, s[16:19], s75 offen lds
s_add_u32 m0, m0, 4096
s_add_u32 s75, s75, 40960
buffer_load_dwordx4 v1, s[16:19], s75 offen lds
s_add_u32 m0, m0, 4096
s_add_u32 s75, s75, 40960
buffer_load_dwordx4 v1, s[16:19], s75 offen lds
s_lshl_b32 s73, s7, 10
s_add_u32 s73, s73, 16384
s_add_u32 m0, s70, s73
s_mov_b32 s75, s72
buffer_load_dwordx4 v1, s[20:23], s75 offen lds
s_add_u32 m0, m0, 4096
s_add_u32 s75, s75, 20480
buffer_load_dwordx4 v1, s[20:23], s75 offen lds
s_add_u32 m0, m0, 4096
s_add_u32 s75, s75, 20480
buffer_load_dwordx4 v1, s[20:23], s75 offen lds
s_add_u32 m0, m0, 4096
s_add_u32 s75, s75, 20480
buffer_load_dwordx4 v1, s[20:23], s75 offen lds
s_add_u32 m0, m0, 4096
s_add_u32 s75, s75, 20480
buffer_load_dwordx4 v1, s[20:23], s75 offen lds
s_add_u32 s72, s72, 128
s_add_u32 s71, s71, 128
s_add_u32 s70, s70, 40960
s_cmp_eq_u32 s70, 122880
s_cselect_b32 s70, 0, s70
s_add_u32 s76, s76, 1
s_cmp_lg_u32 s76, 10
s_cbranch_scc1 L_WRAP_21
s_sub_u32 s71, s71, 1280
s_sub_u32 s72, s72, 1280
s_mov_b32 s76, 0
L_WRAP_21:
s_cmp_lg_u32 s7, 3
s_cbranch_scc1 L_LDS_tA
buffer_load_dwordx4 v[44:47], v41, s[12:15], s78 offen sc1
buffer_load_dwordx4 v[48:51], v41, s[12:15], s78 offen offset:1024 sc1
buffer_load_dwordx2 v[52:53], v43, s[12:15], 0 offen sc1
s_waitcnt vmcnt(12)
s_barrier
s_waitcnt vmcnt(3)
s_barrier
s_waitcnt vmcnt(0)
s_mov_b32 s74, 65536
L_LDS_chk3:
v_xor_b32 v60, s11, v45
v_xor_b32 v61, s11, v47
v_or_b32 v60, v60, v61
v_xor_b32 v61, s11, v49
v_xor_b32 v62, s11, v51
v_or3_b32 v60, v60, v61, v62
v_xor_b32 v61, s11, v53
v_or_b32 v60, v60, v61
v_cmp_ne_u32 vcc, 0, v60
s_cbranch_vccz L_LDS_ok3
s_sub_u32 s74, s74, 1
s_cmp_eq_u32 s74, 0
s_cbranch_scc1 L_LDS_ok3
s_sleep 8
buffer_load_dwordx4 v[44:47], v41, s[12:15], s78 offen sc1
buffer_load_dwordx4 v[48:51], v41, s[12:15], s78 offen offset:1024 sc1
buffer_load_dwordx2 v[52:53], v43, s[12:15], 0 offen sc1
s_waitcnt vmcnt(0)
s_branch L_LDS_chk3
L_LDS_ok3:
v_sub_f32 v60, 0, v44
v_cvt_pk_bf16_f32 v61, v60, v60
v_lshlrev_b32 v63, 16, v61
v_sub_f32 v63, v60, v63
v_cvt_pk_bf16_f32 v62, v63, v63
v_rcp_f32 v64, v46
s_nop 0
v_cvt_pk_bf16_f32 v65, v64, v64
v_lshlrev_b32 v63, 16, v65
v_sub_f32 v63, v64, v63
v_cvt_pk_bf16_f32 v66, v63, v63
s_mov_b32 s76, 0x05040100
v_perm_b32 v68, v62, v61, s76
v_perm_b32 v69, v65, v61, s76
v_and_b32 v70, 0xffff, v66
v_mov_b32 v71, 0
v_lshlrev_b32 v13, 4, v0
v_add_u32 v13, 153600, v13
ds_write_b128 v13, v[68:71]
v_mov_b32 v72, v44
v_mov_b32 v73, v46
v_lshlrev_b32 v13, 3, v0
v_add_u32 v13, 158976, v13
ds_write_b64 v13, v[72:73]
v_lshlrev_b32 v13, 2, v0
v_add_u32 v13, 163200, v13
ds_write_b32 v13, v73
v_sub_f32 v60, 0, v48
v_cvt_pk_bf16_f32 v61, v60, v60
v_lshlrev_b32 v63, 16, v61
v_sub_f32 v63, v60, v63
v_cvt_pk_bf16_f32 v62, v63, v63
v_rcp_f32 v64, v50
s_nop 0
v_cvt_pk_bf16_f32 v65, v64, v64
v_lshlrev_b32 v63, 16, v65
v_sub_f32 v63, v64, v63
v_cvt_pk_bf16_f32 v66, v63, v63
s_mov_b32 s76, 0x05040100
v_perm_b32 v68, v62, v61, s76
v_perm_b32 v69, v65, v61, s76
v_and_b32 v70, 0xffff, v66
v_mov_b32 v71, 0
v_lshlrev_b32 v13, 4, v0
v_add_u32 v13, 154624, v13
ds_write_b128 v13, v[68:71]
v_mov_b32 v72, v48
v_mov_b32 v73, v50
v_lshlrev_b32 v13, 3, v0
v_add_u32 v13, 159488, v13
ds_write_b64 v13, v[72:73]
v_lshlrev_b32 v13, 2, v0
v_add_u32 v13, 163456, v13
ds_write_b32 v13, v73
s_getreg_b32 s73, hwreg(HW_REG_XCC_ID, 0, 4)
v_cmp_ne_u32 vcc, s73, v52
s_cmp_eq_u64 vcc, 0
s_cselect_b32 s73, 1, 0
v_mov_b32 v14, s73
v_mov_b32 v13, 163712
ds_write_b32 v13, v14
s_branch L_LDS_tdone
L_LDS_tA:
buffer_load_dwordx2 v[44:45], v41, s[12:15], s78 offen sc1
s_waitcnt vmcnt(10)
s_barrier
s_waitcnt vmcnt(1)
s_barrier
s_waitcnt vmcnt(0)
s_mov_b32 s74, 65536
L_LDS_chkA:
v_xor_b32 v60, s11, v45
v_cmp_ne_u32 vcc, 0, v60
s_cbranch_vccz L_LDS_okA
s_sub_u32 s74, s74, 1
s_cmp_eq_u32 s74, 0
s_cbranch_scc1 L_LDS_okA
s_sleep 8
buffer_load_dwordx2 v[44:45], v41, s[12:15], s78 offen sc1
s_waitcnt vmcnt(0)
s_branch L_LDS_chkA
L_LDS_okA:
v_cvt_pk_bf16_f32 v45, v44, v44
v_lshlrev_b32 v47, 16, v45
v_sub_f32 v47, v44, v47
v_cvt_pk_bf16_f32 v46, v47, v47
s_mov_b32 s76, 0x05040100
v_perm_b32 v48, v45, v45, s76
v_and_b32 v49, 0xffff, v46
v_mov_b32 v50, 0
v_mov_b32 v51, 0
v_lshlrev_b32 v13, 4, v42
v_add_u32 v13, 155904, v13
ds_write_b128 v13, v[48:51]
L_LDS_tdone:
s_waitcnt lgkmcnt(0)
s_barrier
s_cmp_lg_u32 s7, 3
s_cbranch_scc1 L_EX_work
s_barrier
s_mov_b32 s74, 65536
s_mov_b32 s79, 4096
v_lshlrev_b32 v41, 4, v0
L_EX_f0:
buffer_load_dwordx4 v[56:59], v41, s[12:15], s79 offen sc1
s_waitcnt vmcnt(0)
v_xor_b32 v60, s11, v56
v_xor_b32 v61, s11, v57
v_or_b32 v60, v60, v61
v_xor_b32 v61, s11, v58
v_or_b32 v60, v60, v61
v_xor_b32 v61, s11, v59
v_or_b32 v60, v60, v61
v_cmp_ne_u32 vcc, 0, v60
s_cbranch_vccz L_EX_f0ok
s_sleep 8
s_sub_u32 s74, s74, 1
s_cmp_lg_u32 s74, 0
s_cbranch_scc1 L_EX_f0
L_EX_f0ok:
s_lshr_b32 s73, s2, 3
s_mul_i32 s73, s73, 51200
s_add_u32 s73, s73, 1048576
v_lshlrev_b32 v13, 7, v0
buffer_load_dword v20, v13, s[12:15], s73 offen sc1
s_add_u32 s73, s73, 8192
buffer_load_dword v20, v13, s[12:15], s73 offen sc1
s_add_u32 s73, s73, 8192
buffer_load_dword v20, v13, s[12:15], s73 offen sc1
s_add_u32 s73, s73, 8192
buffer_load_dword v20, v13, s[12:15], s73 offen sc1
s_add_u32 s73, s73, 8192
buffer_load_dword v20, v13, s[12:15], s73 offen sc1
s_add_u32 s73, s73, 8192
buffer_load_dword v20, v13, s[12:15], s73 offen sc1
s_add_u32 s73, s73, 8192
v_min_u32 v14, 15, v0
v_lshlrev_b32 v14, 7, v14
buffer_load_dword v20, v14, s[12:15], s73 offen sc1
s_branch L_EX_done
L_EX_work:
s_lshl_b32 s73, s7, 6
v_add_u32 v42, s73, v0
s_cmp_lg_u32 s7, 2
s_cbranch_scc1 L_EX_full
s_mov_b32 exec_hi, 0
L_EX_full:
v_lshlrev_b32 v13, 2, v42
v_add_u32 v13, 148480, v13
v_lshlrev_b32 v14, 3, v42
v_mov_b32 v52, v80
v_mov_b32 v53, v81
v_and_b32 v16, 1, v0
v_lshlrev_b32 v16, 31, v16
v_or_b32 v16, 0x3f800000, v16
v_mul_f32 v54, v53, v16
v_mov_b32 v58, v52
v_mov_b32 v59, v53
v_mul_f32 v60, v59, v59
v_mul_f32 v61, v58, v59
v_fma_f32 v58, v58, v58, -v60
v_add_f32 v59, v61, v61
v_mul_f32 v60, v59, v59
v_mul_f32 v61, v58, v59
v_fma_f32 v58, v58, v58, -v60
v_add_f32 v59, v61, v61
v_mul_f32 v60, v59, v59
v_mul_f32 v61, v58, v59
v_fma_f32 v58, v58, v58, -v60
v_add_f32 v59, v61, v61
v_mul_f32 v59, v59, v16
s_lshl_b32 s78, s5, 3
s_add_u32 s78, s78, s6
s_mul_i32 s78, s78, 1280
s_add_u32 s78, s78, 131072
v_mov_b32 v64, 0
v_mov_b32 v65, s11
v_mov_b32 v66, 0
v_mov_b32 v67, s11
v_mov_b32 v68, 0
v_mov_b32 v69, s11
v_mov_b32 v70, 0
v_mov_b32 v71, s11
v_mov_b32 v72, 0
v_mov_b32 v73, s11
v_mov_b32 v74, 0
v_mov_b32 v75, s11
v_mov_b32 v76, 0
v_mov_b32 v77, s11
v_mov_b32 v78, 0
v_mov_b32 v79, s11
v_mov_b32 v80, 0
v_mov_b32 v81, s11
v_mov_b32 v82, 0
v_mov_b32 v83, s11
v_mov_b32 v84, 0
v_mov_b32 v85, s11
v_mov_b32 v86, 0
v_mov_b32 v87, s11
v_mov_b32 v88, 0
v_mov_b32 v89, s11
v_mov_b32 v90, 0
v_mov_b32 v91, s11
v_mov_b32 v92, 0
v_mov_b32 v93, s11
s_mov_b64 s[82:83], exec
s_barrier
L_EX_A:
ds_read_b32 v44, v13 offset:0
ds_read_b32 v45, v13 offset:640
ds_read_b32 v46, v13 offset:1280
ds_read_b32 v47, v13 offset:1920
ds_read_b32 v48, v13 offset:2560
ds_read_b32 v49, v13 offset:3200
ds_read_b32 v50, v13 offset:3840
ds_read_b32 v51, v13 offset:4480
s_waitcnt lgkmcnt(0)
v_mov_b32 v56, v44
v_mov_b32 v57, v45
v_fmac_f32 v57, v56, v52
s_nop 1
v_fmac_f32_dpp v57, v56, v54 quad_perm:[1,0,3,2] row_mask:0xf bank_mask:0xf
v_mov_b32 v56, v57
v_mov_b32 v57, v46
v_fmac_f32 v57, v56, v52
s_nop 1
v_fmac_f32_dpp v57, v56, v54 quad_perm:[1,0,3,2] row_mask:0xf bank_mask:0xf
v_mov_b32 v56, v57
v_mov_b32 v57, v47
v_fmac_f32 v57, v56, v52
s_nop 1
v_fmac_f32_dpp v57, v56, v54 quad_perm:[1,0,3,2] row_mask:0xf bank_mask:0xf
v_mov_b32 v56, v57
v_mov_b32 v57, v48
v_fmac_f32 v57, v56, v52
s_nop 1
v_fmac_f32_dpp v57, v56, v54 quad_perm:[1,0,3,2] row_mask:0xf bank_mask:0xf
v_mov_b32 v56, v57
v_mov_b32 v57, v49
v_fmac_f32 v57, v56, v52
s_nop 1
v_fmac_f32_dpp v57, v56, v54 quad_perm:[1,0,3,2] row_mask:0xf bank_mask:0xf
v_mov_b32 v56, v57
v_mov_b32 v57, v50
v_fmac_f32 v57, v56, v52
s_nop 1
v_fmac_f32_dpp v57, v56, v54 quad_perm:[1,0,3,2] row_mask:0xf bank_mask:0xf
v_mov_b32 v56, v57
v_mov_b32 v57, v51
v_fmac_f32 v57, v56, v52
s_nop 1
v_fmac_f32_dpp v57, v56, v54 quad_perm:[1,0,3,2] row_mask:0xf bank_mask:0xf
v_mov_b32 v56, v57
v_mov_b32 v57, s11
buffer_store_dwordx2 v[56:57], v14, s[12:15], s78 offen sc1
s_mov_b32 s74, 65536
L_EX_retry:
s_mov_b32 s75, s78
s_cmp_lt_u32 s5, 1
s_cbranch_scc1 L_EX_iss
s_sub_u32 s75, s75, 10240
buffer_load_dwordx2 v[64:65], v14, s[12:15], s75 offen sc1
s_cmp_lt_u32 s5, 2
s_cbranch_scc1 L_EX_iss
s_sub_u32 s75, s75, 10240
buffer_load_dwordx2 v[66:67], v14, s[12:15], s75 offen sc1
s_cmp_lt_u32 s5, 3
s_cbranch_scc1 L_EX_iss
s_sub_u32 s75, s75, 10240
buffer_load_dwordx2 v[68:69], v14, s[12:15], s75 offen sc1
s_cmp_lt_u32 s5, 4
s_cbranch_scc1 L_EX_iss
s_sub_u32 s75, s75, 10240
buffer_load_dwordx2 v[70:71], v14, s[12:15], s75 offen sc1
s_cmp_lt_u32 s5, 5
s_cbranch_scc1 L_EX_iss
s_sub_u32 s75, s75, 10240
buffer_load_dwordx2 v[72:73], v14, s[12:15], s75 offen sc1
s_cmp_lt_u32 s5, 6
s_cbranch_scc1 L_EX_iss
s_sub_u32 s75, s75, 10240
buffer_load_dwordx2 v[74:75], v14, s[12:15], s75 offen sc1
s_cmp_lt_u32 s5, 7
s_cbranch_scc1 L_EX_iss
s_sub_u32 s75, s75, 10240
buffer_load_dwordx2 v[76:77], v14, s[12:15], s75 offen sc1
s_cmp_lt_u32 s5, 8
s_cbranch_scc1 L_EX_iss
s_sub_u32 s75, s75, 10240
buffer_load_dwordx2 v[78:79], v14, s[12:15], s75 offen sc1
s_cmp_lt_u32 s5, 9
s_cbranch_scc1 L_EX_iss
s_sub_u32 s75, s75, 10240
buffer_load_dwordx2 v[80:81], v14, s[12:15], s75 offen sc1
s_cmp_lt_u32 s5, 10
s_cbranch_scc1 L_EX_iss
s_sub_u32 s75, s75, 10240
buffer_load_dwordx2 v[82:83], v14, s[12:15], s75 offen sc1
s_cmp_lt_u32 s5, 11
s_cbranch_scc1 L_EX_iss
s_sub_u32 s75, s75, 10240
buffer_load_dwordx2 v[84:85], v14, s[12:15], s75 offen sc1
s_cmp_lt_u32 s5, 12
s_cbranch_scc1 L_EX_iss
s_sub_u32 s75, s75, 10240
buffer_load_dwordx2 v[86:87], v14, s[12:15], s75 offen sc1
s_cmp_lt_u32 s5, 13
s_cbranch_scc1 L_EX_iss
s_sub_u32 s75, s75, 10240
buffer_load_dwordx2 v[88:89], v14, s[12:15], s75 offen sc1
s_cmp_lt_u32 s5, 14
s_cbranch_scc1 L_EX_iss
s_sub_u32 s75, s75, 10240
buffer_load_dwordx2 v[90:91], v14, s[12:15], s75 offen sc1
s_cmp_lt_u32 s5, 15
s_cbranch_scc1 L_EX_iss
s_sub_u32 s75, s75, 10240
buffer_load_dwordx2 v[92:93], v14, s[12:15], s75 offen sc1
L_EX_iss:
s_waitcnt vmcnt(0)
v_xor_b32 v60, s11, v65
v_xor_b32 v61, s11, v67
v_or_b32 v60, v60, v61
v_xor_b32 v61, s11, v69
v_or_b32 v60, v60, v61
v_xor_b32 v61, s11, v71
v_or_b32 v60, v60, v61
v_xor_b32 v61, s11, v73
v_or_b32 v60, v60, v61
v_xor_b32 v61, s11, v75
v_or_b32 v60, v60, v61
v_xor_b32 v61, s11, v77
v_or_b32 v60, v60, v61
v_xor_b32 v61, s11, v79
v_or_b32 v60, v60, v61
v_xor_b32 v61, s11, v81
v_or_b32 v60, v60, v61
v_xor_b32 v61, s11, v83
v_or_b32 v60, v60, v61
v_xor_b32 v61, s11, v85
v_or_b32 v60, v60, v61
v_xor_b32 v61, s11, v87
v_or_b32 v60, v60, v61
v_xor_b32 v61, s11, v89
v_or_b32 v60, v60, v61
v_xor_b32 v61, s11, v91
v_or_b32 v60, v60, v61
v_xor_b32 v61, s11, v93
v_or_b32 v60, v60, v61
v_cmp_ne_u32 vcc, 0, v60
s_cbranch_vccz L_EX_go
s_sleep 2
s_sub_u32 s74, s74, 1
s_cmp_lg_u32 s74, 0
s_cbranch_scc1 L_EX_retry
L_EX_go:
L_EX_H:
v_mov_b32 v56, v92
v_fmac_f32 v90, v56, v58
s_nop 1
v_fmac_f32_dpp v90, v56, v59 quad_perm:[1,0,3,2] row_mask:0xf bank_mask:0xf
v_mov_b32 v56, v90
v_fmac_f32 v88, v56, v58
s_nop 1
v_fmac_f32_dpp v88, v56, v59 quad_perm:[1,0,3,2] row_mask:0xf bank_mask:0xf
v_mov_b32 v56, v88
v_fmac_f32 v86, v56, v58
s_nop 1
v_fmac_f32_dpp v86, v56, v59 quad_perm:[1,0,3,2] row_mask:0xf bank_mask:0xf
v_mov_b32 v56, v86
v_fmac_f32 v84, v56, v58
s_nop 1
v_fmac_f32_dpp v84, v56, v59 quad_perm:[1,0,3,2] row_mask:0xf bank_mask:0xf
v_mov_b32 v56, v84
v_fmac_f32 v82, v56, v58
s_nop 1
v_fmac_f32_dpp v82, v56, v59 quad_perm:[1,0,3,2] row_mask:0xf bank_mask:0xf
v_mov_b32 v56, v82
v_fmac_f32 v80, v56, v58
s_nop 1
v_fmac_f32_dpp v80, v56, v59 quad_perm:[1,0,3,2] row_mask:0xf bank_mask:0xf
v_mov_b32 v56, v80
v_fmac_f32 v78, v56, v58
s_nop 1
v_fmac_f32_dpp v78, v56, v59 quad_perm:[1,0,3,2] row_mask:0xf bank_mask:0xf
v_mov_b32 v56, v78
v_fmac_f32 v76, v56, v58
s_nop 1
v_fmac_f32_dpp v76, v56, v59 quad_perm:[1,0,3,2] row_mask:0xf bank_mask:0xf
v_mov_b32 v56, v76
v_fmac_f32 v74, v56, v58
s_nop 1
v_fmac_f32_dpp v74, v56, v59 quad_perm:[1,0,3,2] row_mask:0xf bank_mask:0xf
v_mov_b32 v56, v74
v_fmac_f32 v72, v56, v58
s_nop 1
v_fmac_f32_dpp v72, v56, v59 quad_perm:[1,0,3,2] row_mask:0xf bank_mask:0xf
v_mov_b32 v56, v72
v_fmac_f32 v70, v56, v58
s_nop 1
v_fmac_f32_dpp v70, v56, v59 quad_perm:[1,0,3,2] row_mask:0xf bank_mask:0xf
v_mov_b32 v56, v70
v_fmac_f32 v68, v56, v58
s_nop 1
v_fmac_f32_dpp v68, v56, v59 quad_perm:[1,0,3,2] row_mask:0xf bank_mask:0xf
v_mov_b32 v56, v68
v_fmac_f32 v66, v56, v58
s_nop 1
v_fmac_f32_dpp v66, v56, v59 quad_perm:[1,0,3,2] row_mask:0xf bank_mask:0xf
v_mov_b32 v56, v66
v_fmac_f32 v64, v56, v58
s_nop 1
v_fmac_f32_dpp v64, v56, v59 quad_perm:[1,0,3,2] row_mask:0xf bank_mask:0xf
v_mov_b32 v56, v64
ds_write_b32 v13, v56 offset:0
v_fmac_f32 v44, v56, v52
s_nop 1
v_fmac_f32_dpp v44, v56, v54 quad_perm:[1,0,3,2] row_mask:0xf bank_mask:0xf
v_mov_b32 v56, v44
ds_write_b32 v13, v56 offset:640
v_fmac_f32 v45, v56, v52
s_nop 1
v_fmac_f32_dpp v45, v56, v54 quad_perm:[1,0,3,2] row_mask:0xf bank_mask:0xf
v_mov_b32 v56, v45
ds_write_b32 v13, v56 offset:1280
v_fmac_f32 v46, v56, v52
s_nop 1
v_fmac_f32_dpp v46, v56, v54 quad_perm:[1,0,3,2] row_mask:0xf bank_mask:0xf
v_mov_b32 v56, v46
ds_write_b32 v13, v56 offset:1920
v_fmac_f32 v47, v56, v52
s_nop 1
v_fmac_f32_dpp v47, v56, v54 quad_perm:[1,0,3,2] row_mask:0xf bank_mask:0xf
v_mov_b32 v56, v47
ds_write_b32 v13, v56 offset:2560
v_fmac_f32 v48, v56, v52
s_nop 1
v_fmac_f32_dpp v48, v56, v54 quad_perm:[1,0,3,2] row_mask:0xf bank_mask:0xf
v_mov_b32 v56, v48
ds_write_b32 v13, v56 offset:3200
v_fmac_f32 v49, v56, v52
s_nop 1
v_fmac_f32_dpp v49, v56, v54 quad_perm:[1,0,3,2] row_mask:0xf bank_mask:0xf
v_mov_b32 v56, v49
ds_write_b32 v13, v56 offset:3840
v_fmac_f32 v50, v56, v52
s_nop 1
v_fmac_f32_dpp v50, v56, v54 quad_perm:[1,0,3,2] row_mask:0xf bank_mask:0xf
v_mov_b32 v56, v50
ds_write_b32 v13, v56 offset:4480
s_mov_b64 exec, -1
s_waitcnt lgkmcnt(0)
L_EX_done:
s_barrier
s_add_u32 s73, s10, 0
s_and_b32 s73, s73, 3
s_lshl_b32 s75, s9, 2
s_add_u32 s75, s75, s10
s_lshl_b32 s75, s75, 2
s_add_u32 s73, s73, s75
s_lshl_b32 s73, s73, 1
s_add_u32 s73, s73, 0
s_mul_i32 s73, s73, 25600
s_add_u32 s73, s73, 1048576
s_lshl_b32 s75, s7, 10
s_add_u32 s73, s73, s75
s_add_u32 m0, s75, 122880
s_nop 0
buffer_load_dwordx4 v5, s[12:15], s73 offen sc1 nt lds
s_add_u32 m0, m0, 4096
s_add_u32 s73, s73, 4096
s_nop 0
buffer_load_dwordx4 v5, s[12:15], s73 offen sc1 nt lds
s_add_u32 m0, m0, 4096
s_add_u32 s73, s73, 4096
s_nop 0
buffer_load_dwordx4 v5, s[12:15], s73 offen sc1 nt lds
s_add_u32 m0, m0, 4096
s_add_u32 s73, s73, 4096
s_nop 0
buffer_load_dwordx4 v5, s[12:15], s73 offen sc1 nt lds
s_add_u32 m0, m0, 4096
s_add_u32 s73, s73, 4096
s_nop 0
buffer_load_dwordx4 v5, s[12:15], s73 offen sc1 nt lds
s_add_u32 m0, m0, 4096
s_add_u32 s73, s73, 4096
s_nop 0
buffer_load_dwordx4 v5, s[12:15], s73 offen sc1 nt lds
s_add_u32 m0, m0, 4096
s_add_u32 s73, s73, 4096
s_cmp_ge_u32 s7, 1
s_cbranch_scc1 L_i2skip_S0
s_nop 0
buffer_load_dwordx4 v5, s[12:15], s73 offen sc1 nt lds
L_i2skip_S0:
s_add_u32 s73, s10, 0
s_and_b32 s73, s73, 3
s_lshl_b32 s75, s9, 2
s_add_u32 s75, s75, s10
s_lshl_b32 s75, s75, 2
s_add_u32 s73, s73, s75
s_lshl_b32 s73, s73, 1
s_add_u32 s73, s73, 1
s_mul_i32 s73, s73, 25600
s_add_u32 s73, s73, 1048576
s_lshl_b32 s75, s7, 10
s_add_u32 s73, s73, s75
s_add_u32 m0, s75, 0
s_nop 0
buffer_load_dwordx4 v5, s[12:15], s73 offen sc1 nt lds
s_add_u32 m0, m0, 4096
s_add_u32 s73, s73, 4096
s_nop 0
buffer_load_dwordx4 v5, s[12:15], s73 offen sc1 nt lds
s_add_u32 m0, m0, 4096
s_add_u32 s73, s73, 4096
s_nop 0
buffer_load_dwordx4 v5, s[12:15], s73 offen sc1 nt lds
s_add_u32 m0, m0, 4096
s_add_u32 s73, s73, 4096
s_nop 0
buffer_load_dwordx4 v5, s[12:15], s73 offen sc1 nt lds
s_add_u32 m0, m0, 4096
s_add_u32 s73, s73, 4096
s_nop 0
buffer_load_dwordx4 v5, s[12:15], s73 offen sc1 nt lds
s_add_u32 m0, m0, 4096
s_add_u32 s73, s73, 4096
s_nop 0
buffer_load_dwordx4 v5, s[12:15], s73 offen sc1 nt lds
s_add_u32 m0, m0, 4096
s_add_u32 s73, s73, 4096
s_cmp_ge_u32 s7, 1
s_cbranch_scc1 L_i2skip_S1
s_nop 0
buffer_load_dwordx4 v5, s[12:15], s73 offen sc1 nt lds
L_i2skip_S1:
s_add_u32 s73, s10, 1
s_and_b32 s73, s73, 3
s_lshl_b32 s75, s9, 2
s_add_u32 s75, s75, s10
s_lshl_b32 s75, s75, 2
s_add_u32 s73, s73, s75
s_lshl_b32 s73, s73, 1
s_add_u32 s73, s73, 0
s_mul_i32 s73, s73, 25600
s_add_u32 s73, s73, 1048576
s_lshl_b32 s75, s7, 10
s_add_u32 s73, s73, s75
s_add_u32 m0, s75, 25600
s_nop 0
buffer_load_dwordx4 v5, s[12:15], s73 offen sc1 nt lds
s_add_u32 m0, m0, 4096
s_add_u32 s73, s73, 4096
s_nop 0
buffer_load_dwordx4 v5, s[12:15], s73 offen sc1 nt lds
s_add_u32 m0, m0, 4096
s_add_u32 s73, s73, 4096
s_nop 0
buffer_load_dwordx4 v5, s[12:15], s73 offen sc1 nt lds
s_add_u32 m0, m0, 4096
s_add_u32 s73, s73, 4096
s_nop 0
buffer_load_dwordx4 v5, s[12:15], s73 offen sc1 nt lds
s_add_u32 m0, m0, 4096
s_add_u32 s73, s73, 4096
s_nop 0
buffer_load_dwordx4 v5, s[12:15], s73 offen sc1 nt lds
s_add_u32 m0, m0, 4096
s_add_u32 s73, s73, 4096
s_nop 0
buffer_load_dwordx4 v5, s[12:15], s73 offen sc1 nt lds
s_add_u32 m0, m0, 4096
s_add_u32 s73, s73, 4096
s_cmp_ge_u32 s7, 1
s_cbranch_scc1 L_i2skip_S2
s_nop 0
buffer_load_dwordx4 v5, s[12:15], s73 offen sc1 nt lds
L_i2skip_S2:
s_add_u32 s73, s10, 1
s_and_b32 s73, s73, 3
s_lshl_b32 s75, s9, 2
s_add_u32 s75, s75, s10
s_lshl_b32 s75, s75, 2
s_add_u32 s73, s73, s75
s_lshl_b32 s73, s73, 1
s_add_u32 s73, s73, 1
s_mul_i32 s73, s73, 25600
s_add_u32 s73, s73, 1048576
s_lshl_b32 s75, s7, 10
s_add_u32 s73, s73, s75
s_add_u32 m0, s75, 51200
s_nop 0
buffer_load_dwordx4 v5, s[12:15], s73 offen sc1 nt lds
s_add_u32 m0, m0, 4096
s_add_u32 s73, s73, 4096
s_nop 0
buffer_load_dwordx4 v5, s[12:15], s73 offen sc1 nt lds
s_add_u32 m0, m0, 4096
s_add_u32 s73, s73, 4096
s_nop 0
buffer_load_dwordx4 v5, s[12:15], s73 offen sc1 nt lds
s_add_u32 m0, m0, 4096
s_add_u32 s73, s73, 4096
s_nop 0
buffer_load_dwordx4 v5, s[12:15], s73 offen sc1 nt lds
s_add_u32 m0, m0, 4096
s_add_u32 s73, s73, 4096
s_nop 0
buffer_load_dwordx4 v5, s[12:15], s73 offen sc1 nt lds
s_add_u32 m0, m0, 4096
s_add_u32 s73, s73, 4096
s_nop 0
buffer_load_dwordx4 v5, s[12:15], s73 offen sc1 nt lds
s_add_u32 m0, m0, 4096
s_add_u32 s73, s73, 4096
s_cmp_ge_u32 s7, 1
s_cbranch_scc1 L_i2skip_S3
s_nop 0
buffer_load_dwordx4 v5, s[12:15], s73 offen sc1 nt lds
L_i2skip_S3:
s_waitcnt vmcnt(18)
s_barrier
s_add_u32 s73, s10, 2
s_and_b32 s73, s73, 3
s_lshl_b32 s75, s9, 2
s_add_u32 s75, s75, s10
s_lshl_b32 s75, s75, 2
s_add_u32 s73, s73, s75
s_lshl_b32 s73, s73, 1
s_add_u32 s73, s73, 0
s_mul_i32 s73, s73, 25600
s_add_u32 s73, s73, 1048576
s_lshl_b32 s75, s7, 10
s_add_u32 s73, s73, s75
s_add_u32 m0, s75, 76800
s_nop 0
buffer_load_dwordx4 v5, s[12:15], s73 offen sc1 nt lds
s_add_u32 m0, m0, 4096
s_add_u32 s73, s73, 4096
s_nop 0
buffer_load_dwordx4 v5, s[12:15], s73 offen sc1 nt lds
s_add_u32 m0, m0, 4096
s_add_u32 s73, s73, 4096
s_nop 0
buffer_load_dwordx4 v5, s[12:15], s73 offen sc1 nt lds
s_add_u32 m0, m0, 4096
s_add_u32 s73, s73, 4096
s_nop 0
buffer_load_dwordx4 v5, s[12:15], s73 offen sc1 nt lds
s_add_u32 m0, m0, 4096
s_add_u32 s73, s73, 4096
s_nop 0
buffer_load_dwordx4 v5, s[12:15], s73 offen sc1 nt lds
s_add_u32 m0, m0, 4096
s_add_u32 s73, s73, 4096
s_nop 0
buffer_load_dwordx4 v5, s[12:15], s73 offen sc1 nt lds
s_add_u32 m0, m0, 4096
s_add_u32 s73, s73, 4096
s_cmp_ge_u32 s7, 1
s_cbranch_scc1 L_i2skip_S4
s_nop 0
buffer_load_dwordx4 v5, s[12:15], s73 offen sc1 nt lds
L_i2skip_S4:
s_waitcnt vmcnt(18)
s_barrier
s_add_u32 s73, s10, 2
s_and_b32 s73, s73, 3
s_lshl_b32 s75, s9, 2
s_add_u32 s75, s75, s10
s_lshl_b32 s75, s75, 2
s_add_u32 s73, s73, s75
s_lshl_b32 s73, s73, 1
s_add_u32 s73, s73, 1
s_mul_i32 s73, s73, 25600
s_add_u32 s73, s73, 1048576
s_lshl_b32 s75, s7, 10
s_add_u32 s73, s73, s75
s_add_u32 m0, s75, 122880
s_nop 0
buffer_load_dwordx4 v5, s[12:15], s73 offen sc1 nt lds
s_add_u32 m0, m0, 4096
s_add_u32 s73, s73, 4096
s_nop 0
buffer_load_dwordx4 v5, s[12:15], s73 offen sc1 nt lds
s_add_u32 m0, m0, 4096
s_add_u32 s73, s73, 4096
s_nop 0
buffer_load_dwordx4 v5, s[12:15], s73 offen sc1 nt lds
s_add_u32 m0, m0, 4096
s_add_u32 s73, s73, 4096
s_nop 0
buffer_load_dwordx4 v5, s[12:15], s73 offen sc1 nt lds
s_add_u32 m0, m0, 4096
s_add_u32 s73, s73, 4096
s_nop 0
buffer_load_dwordx4 v5, s[12:15], s73 offen sc1 nt lds
s_add_u32 m0, m0, 4096
s_add_u32 s73, s73, 4096
s_nop 0
buffer_load_dwordx4 v5, s[12:15], s73 offen sc1 nt lds
s_add_u32 m0, m0, 4096
s_add_u32 s73, s73, 4096
s_cmp_ge_u32 s7, 1
s_cbranch_scc1 L_i2skip_S5
s_nop 0
buffer_load_dwordx4 v5, s[12:15], s73 offen sc1 nt lds
L_i2skip_S5:
s_waitcnt vmcnt(18)
s_barrier
s_add_u32 s73, s10, 3
s_and_b32 s73, s73, 3
s_lshl_b32 s75, s9, 2
s_add_u32 s75, s75, s10
s_lshl_b32 s75, s75, 2
s_add_u32 s73, s73, s75
s_lshl_b32 s73, s73, 1
s_add_u32 s73, s73, 0
s_mul_i32 s73, s73, 25600
s_add_u32 s73, s73, 1048576
s_lshl_b32 s75, s7, 10
s_add_u32 s73, s73, s75
s_add_u32 m0, s75, 0
s_nop 0
buffer_load_dwordx4 v5, s[12:15], s73 offen sc1 nt lds
s_add_u32 m0, m0, 4096
s_add_u32 s73, s73, 4096
s_nop 0
buffer_load_dwordx4 v5, s[12:15], s73 offen sc1 nt lds
s_add_u32 m0, m0, 4096
s_add_u32 s73, s73, 4096
s_nop 0
buffer_load_dwordx4 v5, s[12:15], s73 offen sc1 nt lds
s_add_u32 m0, m0, 4096
s_add_u32 s73, s73, 4096
s_nop 0
buffer_load_dwordx4 v5, s[12:15], s73 offen sc1 nt lds
s_add_u32 m0, m0, 4096
s_add_u32 s73, s73, 4096
s_nop 0
buffer_load_dwordx4 v5, s[12:15], s73 offen sc1 nt lds
s_add_u32 m0, m0, 4096
s_add_u32 s73, s73, 4096
s_nop 0
buffer_load_dwordx4 v5, s[12:15], s73 offen sc1 nt lds
s_add_u32 m0, m0, 4096
s_add_u32 s73, s73, 4096
s_cmp_ge_u32 s7, 1
s_cbranch_scc1 L_i2skip_S6
s_nop 0
buffer_load_dwordx4 v5, s[12:15], s73 offen sc1 nt lds
L_i2skip_S6:
s_waitcnt vmcnt(18)
s_barrier
s_add_u32 s73, s10, 3
s_and_b32 s73, s73, 3
s_lshl_b32 s75, s9, 2
s_add_u32 s75, s75, s10
s_lshl_b32 s75, s75, 2
s_add_u32 s73, s73, s75
s_lshl_b32 s73, s73, 1
s_add_u32 s73, s73, 1
s_mul_i32 s73, s73, 25600
s_add_u32 s73, s73, 1048576
s_lshl_b32 s75, s7, 10
s_add_u32 s73, s73, s75
s_add_u32 m0, s75, 25600
s_nop 0
buffer_load_dwordx4 v5, s[12:15], s73 offen sc1 nt lds
s_add_u32 m0, m0, 4096
s_add_u32 s73, s73, 4096
s_nop 0
buffer_load_dwordx4 v5, s[12:15], s73 offen sc1 nt lds
s_add_u32 m0, m0, 4096
s_add_u32 s73, s73, 4096
s_nop 0
buffer_load_dwordx4 v5, s[12:15], s73 offen sc1 nt lds
s_add_u32 m0, m0, 4096
s_add_u32 s73, s73, 4096
s_nop 0
buffer_load_dwordx4 v5, s[12:15], s73 offen sc1 nt lds
s_add_u32 m0, m0, 4096
s_add_u32 s73, s73, 4096
s_nop 0
buffer_load_dwordx4 v5, s[12:15], s73 offen sc1 nt lds
s_add_u32 m0, m0, 4096
s_add_u32 s73, s73, 4096
s_nop 0
buffer_load_dwordx4 v5, s[12:15], s73 offen sc1 nt lds
s_add_u32 m0, m0, 4096
s_add_u32 s73, s73, 4096
s_cmp_ge_u32 s7, 1
s_cbranch_scc1 L_i2skip_S7
s_nop 0
buffer_load_dwordx4 v5, s[12:15], s73 offen sc1 nt lds
L_i2skip_S7:
s_waitcnt vmcnt(18)
s_barrier
s_waitcnt vmcnt(12)
s_barrier
s_waitcnt vmcnt(6)
s_barrier
s_waitcnt vmcnt(0)
s_barrier
s_cmp_lg_u32 s2, 0
s_cbranch_scc1 L_LDS_nb
s_cmp_lg_u32 s7, 0
s_cbranch_scc1 L_LDS_nb
v_mov_b32 v13, s11
s_mov_b64 exec, 1
buffer_store_dword v13, off, s[12:15], 0 sc1
s_mov_b64 exec, -1
L_LDS_nb:
s_endpgm
L_LOADER_G:
buffer_load_dword v40, off, s[12:15], 0 sc1
s_cmp_lg_u32 s7, 3
s_cbranch_scc1 L_LDG_e0
v_lshlrev_b32 v13, 4, v0
s_mul_i32 s73, s10, 320
s_mov_b32 exec_lo, 0xfffff
s_mov_b32 exec_hi, 0
s_mov_b32 s28, s52
s_mov_b32 s29, s53
s_mov_b32 s30, 1280
s_mov_b32 s31, 0x20000
s_mov_b32 m0, 162560
s_nop 0
buffer_load_dwordx4 v13, s[28:31], s73 offen lds
s_mov_b32 s28, s62
s_mov_b32 s29, s63
s_mov_b32 s30, 1280
s_mov_b32 s31, 0x20000
s_mov_b32 m0, 162880
s_nop 0
buffer_load_dwordx4 v13, s[28:31], s73 offen lds
s_mov_b64 exec, -1
L_LDG_e0:
s_and_b32 s73, s7, 1
s_lshl_b32 s73, s73, 2
v_lshrrev_b32 v2, 4, v0
v_add_u32 v2, s73, v2
v_and_b32 v2, 7, v2
v_and_b32 v3, 7, v0
v_xor_b32 v2, v2, v3
v_lshlrev_b32 v2, 4, v2
v_lshrrev_b32 v3, 3, v0
v_mul_u32_u24 v3, 1280, v3
v_add_u32 v1, v2, v3
s_lshl_b32 s71, s5, 7
s_lshl_b32 s73, s7, 3
s_add_u32 s71, s71, s73
s_mul_i32 s71, s71, 1280
s_and_b32 s76, s5, 3
s_mul_i32 s76, s76, 1
s_add_u32 s76, s76, s6
s_cmp_ge_u32 s76, 10
s_cselect_b32 s73, 10, 0
s_sub_u32 s76, s76, s73
s_lshl_b32 s73, s76, 7
s_add_u32 s71, s71, s73
s_mov_b32 s20, s56
s_mov_b32 s21, s57
s_mov_b32 s22, 1966080
s_mov_b32 s23, 0x20000
s_lshl_b32 s72, s7, 4
s_mul_i32 s72, s72, 3072
s_mul_i32 s73, s6, 384
s_add_u32 s72, s72, s73
v_lshlrev_b32 v13, 4, v0
v_add_u32 v13, 0, v13
v_mul_u32_u24 v14, 43691, v13
v_lshrrev_b32 v14, 24, v14
v_mul_u32_u24 v15, 384, v14
v_sub_u32 v15, v13, v15
v_lshrrev_b32 v16, 1, v14
v_and_b32 v16, 1, v16
v_lshlrev_b32 v16, 6, v16
v_xor_b32 v15, v15, v16
v_mul_u32_u24 v14, 3072, v14
v_add_u32 v2, v14, v15
v_lshlrev_b32 v13, 4, v0
v_add_u32 v13, 1024, v13
v_mul_u32_u24 v14, 43691, v13
v_lshrrev_b32 v14, 24, v14
v_mul_u32_u24 v15, 384, v14
v_sub_u32 v15, v13, v15
v_lshrrev_b32 v16, 1, v14
v_and_b32 v16, 1, v16
v_lshlrev_b32 v16, 6, v16
v_xor_b32 v15, v15, v16
v_mul_u32_u24 v14, 3072, v14
v_add_u32 v3, v14, v15
v_lshlrev_b32 v13, 4, v0
v_add_u32 v13, 2048, v13
v_mul_u32_u24 v14, 43691, v13
v_lshrrev_b32 v14, 24, v14
v_mul_u32_u24 v15, 384, v14
v_sub_u32 v15, v13, v15
v_lshrrev_b32 v16, 1, v14
v_and_b32 v16, 1, v16
v_lshlrev_b32 v16, 6, v16
v_xor_b32 v15, v15, v16
v_mul_u32_u24 v14, 3072, v14
v_add_u32 v4, v14, v15
s_mul_i32 s73, s76, 196608
s_add_u32 s72, s72, s73
s_mov_b32 s70, 81920
s_lshl_b32 s73, s7, 10
s_add_u32 m0, s70, s73
s_mov_b32 s75, s71
buffer_load_dwordx4 v1, s[16:19], s75 offen lds
s_add_u32 m0, m0, 4096
s_add_u32 s75, s75, 40960
buffer_load_dwordx4 v1, s[16:19], s75 offen lds
s_add_u32 m0, m0, 4096
s_add_u32 s75, s75, 40960
buffer_load_dwordx4 v1, s[16:19], s75 offen lds
s_add_u32 m0, m0, 4096
s_add_u32 s75, s75, 40960
buffer_load_dwordx4 v1, s[16:19], s75 offen lds
s_mul_i32 s73, s7, 6144
s_add_u32 s73, s73, 16384
s_add_u32 m0, s70, s73
s_mov_b32 s75, s72
s_nop 0
buffer_load_dwordx4 v2, s[20:23], s75 offen lds
s_add_u32 m0, m0, 1024
s_nop 0
buffer_load_dwordx4 v3, s[20:23], s75 offen lds
s_add_u32 m0, m0, 1024
s_nop 0
buffer_load_dwordx4 v4, s[20:23], s75 offen lds
s_add_u32 m0, m0, 1024
s_add_u32 s75, s75, 24576
s_nop 0
buffer_load_dwordx4 v2, s[20:23], s75 offen lds
s_add_u32 m0, m0, 1024
s_nop 0
buffer_load_dwordx4 v3, s[20:23], s75 offen lds
s_add_u32 m0, m0, 1024
s_nop 0
buffer_load_dwordx4 v4, s[20:23], s75 offen lds
s_add_u32 s72, s72, 196608
s_add_u32 s71, s71, 128
s_add_u32 s70, s70, 40960
s_cmp_eq_u32 s70, 122880
s_cselect_b32 s70, 0, s70
s_add_u32 s76, s76, 1
s_cmp_lg_u32 s76, 10
s_cbranch_scc1 L_WRAP_22
s_sub_u32 s71, s71, 1280
s_sub_u32 s72, s72, 1966080
s_mov_b32 s76, 0
L_WRAP_22:
s_mov_b32 s24, s60
s_mov_b32 s25, s61
s_mov_b32 s26, 1966080
s_mov_b32 s27, 0x20000
s_lshl_b32 s73, s7, 10
s_add_u32 s73, s73, 0
v_lshl_add_u32 v13, v0, 4, s73
v_cmp_le_u32 vcc, 15360, v13
s_nop 1
v_cndmask_b32 v14, 0, 1, vcc
v_mul_u32_u24 v15, 15360, v14
v_sub_u32 v13, v13, v15
v_mul_u32_u24 v15, 52429, v13
v_lshrrev_b32 v15, 24, v15
v_mul_u32_u24 v16, 320, v15
v_sub_u32 v13, v13, v16
v_mad_u32_u24 v15, v14, 48, v15
v_mad_u32_u24 v15, v14, 48, v15
v_mul_u32_u24 v15, 1280, v15
v_add_u32 v5, v15, v13
s_lshl_b32 s73, s7, 10
s_add_u32 s73, s73, 4096
v_lshl_add_u32 v13, v0, 4, s73
v_cmp_le_u32 vcc, 15360, v13
s_nop 1
v_cndmask_b32 v14, 0, 1, vcc
v_mul_u32_u24 v15, 15360, v14
v_sub_u32 v13, v13, v15
v_mul_u32_u24 v15, 52429, v13
v_lshrrev_b32 v15, 24, v15
v_mul_u32_u24 v16, 320, v15
v_sub_u32 v13, v13, v16
v_mad_u32_u24 v15, v14, 48, v15
v_mad_u32_u24 v15, v14, 48, v15
v_mul_u32_u24 v15, 1280, v15
v_add_u32 v6, v15, v13
s_lshl_b32 s73, s7, 10
s_add_u32 s73, s73, 8192
v_lshl_add_u32 v13, v0, 4, s73
v_cmp_le_u32 vcc, 15360, v13
s_nop 1
v_cndmask_b32 v14, 0, 1, vcc
v_mul_u32_u24 v15, 15360, v14
v_sub_u32 v13, v13, v15
v_mul_u32_u24 v15, 52429, v13
v_lshrrev_b32 v15, 24, v15
v_mul_u32_u24 v16, 320, v15
v_sub_u32 v13, v13, v16
v_mad_u32_u24 v15, v14, 48, v15
v_mad_u32_u24 v15, v14, 48, v15
v_mul_u32_u24 v15, 1280, v15
v_add_u32 v7, v15, v13
s_lshl_b32 s73, s7, 10
s_add_u32 s73, s73, 12288
v_lshl_add_u32 v13, v0, 4, s73
v_cmp_le_u32 vcc, 15360, v13
s_nop 1
v_cndmask_b32 v14, 0, 1, vcc
v_mul_u32_u24 v15, 15360, v14
v_sub_u32 v13, v13, v15
v_mul_u32_u24 v15, 52429, v13
v_lshrrev_b32 v15, 24, v15
v_mul_u32_u24 v16, 320, v15
v_sub_u32 v13, v13, v16
v_mad_u32_u24 v15, v14, 48, v15
v_mad_u32_u24 v15, v14, 48, v15
v_mul_u32_u24 v15, 1280, v15
v_add_u32 v8, v15, v13
s_lshl_b32 s73, s7, 10
s_add_u32 s73, s73, 16384
v_lshl_add_u32 v13, v0, 4, s73
v_cmp_le_u32 vcc, 15360, v13
s_nop 1
v_cndmask_b32 v14, 0, 1, vcc
v_mul_u32_u24 v15, 15360, v14
v_sub_u32 v13, v13, v15
v_mul_u32_u24 v15, 52429, v13
v_lshrrev_b32 v15, 24, v15
v_mul_u32_u24 v16, 320, v15
v_sub_u32 v13, v13, v16
v_mad_u32_u24 v15, v14, 48, v15
v_mad_u32_u24 v15, v14, 48, v15
v_mul_u32_u24 v15, 1280, v15
v_add_u32 v9, v15, v13
s_lshl_b32 s73, s7, 10
s_add_u32 s73, s73, 20480
v_lshl_add_u32 v13, v0, 4, s73
v_cmp_le_u32 vcc, 15360, v13
s_nop 1
v_cndmask_b32 v14, 0, 1, vcc
v_mul_u32_u24 v15, 15360, v14
v_sub_u32 v13, v13, v15
v_mul_u32_u24 v15, 52429, v13
v_lshrrev_b32 v15, 24, v15
v_mul_u32_u24 v16, 320, v15
v_sub_u32 v13, v13, v16
v_mad_u32_u24 v15, v14, 48, v15
v_mad_u32_u24 v15, v14, 48, v15
v_mul_u32_u24 v15, 1280, v15
v_add_u32 v10, v15, v13
s_lshl_b32 s73, s7, 10
s_add_u32 s73, s73, 24576
v_lshl_add_u32 v13, v0, 4, s73
v_cmp_le_u32 vcc, 15360, v13
s_nop 1
v_cndmask_b32 v14, 0, 1, vcc
v_mul_u32_u24 v15, 15360, v14
v_sub_u32 v13, v13, v15
v_mul_u32_u24 v15, 52429, v13
v_lshrrev_b32 v15, 24, v15
v_mul_u32_u24 v16, 320, v15
v_sub_u32 v13, v13, v16
v_mad_u32_u24 v15, v14, 48, v15
v_mad_u32_u24 v15, v14, 48, v15
v_mul_u32_u24 v15, 1280, v15
v_add_u32 v11, v15, v13
s_lshl_b32 s73, s7, 10
s_add_u32 s73, s73, 28672
v_lshl_add_u32 v13, v0, 4, s73
v_cmp_le_u32 vcc, 15360, v13
s_nop 1
v_cndmask_b32 v14, 0, 1, vcc
v_mul_u32_u24 v15, 15360, v14
v_sub_u32 v13, v13, v15
v_mul_u32_u24 v15, 52429, v13
v_lshrrev_b32 v15, 24, v15
v_mul_u32_u24 v16, 320, v15
v_sub_u32 v13, v13, v16
v_mad_u32_u24 v15, v14, 48, v15
v_mad_u32_u24 v15, v14, 48, v15
v_mul_u32_u24 v15, 1280, v15
v_add_u32 v12, v15, v13
v_mov_b32 v16, 0
v_mov_b32 v17, 0
v_mov_b32 v18, 0
v_mov_b32 v19, 0
v_mov_b32 v13, 155648
ds_write_b128 v13, v[16:19]
s_cmp_eq_u32 s7, 3
s_cbranch_scc1 L_LDG_ga3
s_lshl_b32 s73, s7, 6
v_add_u32 v42, s73, v0
v_min_u32 v42, 191, v42
v_lshlrev_b32 v41, 3, v42
s_mul_i32 s78, s6, 1536
s_add_u32 s78, s78, 393216
s_mul_i32 s73, s6, 192
v_add_u32 v43, s73, v42
v_lshlrev_b32 v43, 1, v43
s_branch L_LDG_ga4
L_LDG_ga3:
v_lshlrev_b32 v41, 4, v0
s_lshl_b32 s78, s5, 11
s_add_u32 s78, s78, 8192
v_mov_b32 v42, v0
s_lshr_b32 s73, s2, 3
s_and_b32 s73, s73, 24
s_lshl_b32 s73, s73, 3
s_and_b32 s75, s2, 7
s_add_u32 s73, s73, s75
v_and_b32 v43, 7, v0
v_lshl_add_u32 v43, v43, 3, s73
v_lshlrev_b32 v43, 3, v43
v_add_u32 v43, 57344, v43
L_LDG_ga4:
s_mov_b32 s74, 0
L_LDG_LOOP:
s_waitcnt vmcnt(10) lgkmcnt(0)
s_cmp_lg_u32 s74, 0
s_cbranch_scc1 L_LDG_n0
s_waitcnt vmcnt(0)
v_readfirstlane_b32 s11, v40
s_mul_i32 s11, s11, 1664525
s_add_u32 s11, s11, 1013904223
L_LDG_n0:
s_barrier
s_cmp_eq_u32 s74, 7
s_cbranch_scc1 L_LDG_tail
s_cmp_lg_u32 s74, 0
s_cbranch_scc1 L_LDG_e1x
s_lshl_b32 s73, s7, 10
s_add_u32 m0, s70, s73
s_mov_b32 s75, s71
buffer_load_dwordx4 v1, s[16:19], s75 offen lds
s_add_u32 m0, m0, 4096
s_add_u32 s75, s75, 40960
buffer_load_dwordx4 v1, s[16:19], s75 offen lds
s_add_u32 m0, m0, 4096
s_add_u32 s75, s75, 40960
buffer_load_dwordx4 v1, s[16:19], s75 offen lds
s_add_u32 m0, m0, 4096
s_add_u32 s75, s75, 40960
buffer_load_dwordx4 v1, s[16:19], s75 offen lds
s_mul_i32 s73, s7, 6144
s_add_u32 s73, s73, 16384
s_add_u32 m0, s70, s73
s_mov_b32 s75, s72
s_nop 0
buffer_load_dwordx4 v2, s[20:23], s75 offen lds
s_add_u32 m0, m0, 1024
s_nop 0
buffer_load_dwordx4 v3, s[20:23], s75 offen lds
s_add_u32 m0, m0, 1024
s_nop 0
buffer_load_dwordx4 v4, s[20:23], s75 offen lds
s_add_u32 m0, m0, 1024
s_add_u32 s75, s75, 24576
s_nop 0
buffer_load_dwordx4 v2, s[20:23], s75 offen lds
s_add_u32 m0, m0, 1024
s_nop 0
buffer_load_dwordx4 v3, s[20:23], s75 offen lds
s_add_u32 m0, m0, 1024
s_nop 0
buffer_load_dwordx4 v4, s[20:23], s75 offen lds
s_add_u32 s72, s72, 196608
s_add_u32 s71, s71, 128
s_add_u32 s70, s70, 40960
s_cmp_eq_u32 s70, 122880
s_cselect_b32 s70, 0, s70
s_add_u32 s76, s76, 1
s_cmp_lg_u32 s76, 10
s_cbranch_scc1 L_WRAP_23
s_sub_u32 s71, s71, 1280
s_sub_u32 s72, s72, 1966080
s_mov_b32 s76, 0
L_WRAP_23:
L_LDG_e1x:
s_lshl_b32 s73, s7, 10
s_add_u32 m0, s70, s73
s_mov_b32 s75, s71
buffer_load_dwordx4 v1, s[16:19], s75 offen lds
s_add_u32 m0, m0, 4096
s_add_u32 s75, s75, 40960
buffer_load_dwordx4 v1, s[16:19], s75 offen lds
s_add_u32 m0, m0, 4096
s_add_u32 s75, s75, 40960
buffer_load_dwordx4 v1, s[16:19], s75 offen lds
s_add_u32 m0, m0, 4096
s_add_u32 s75, s75, 40960
buffer_load_dwordx4 v1, s[16:19], s75 offen lds
s_mul_i32 s73, s7, 6144
s_add_u32 s73, s73, 16384
s_add_u32 m0, s70, s73
s_mov_b32 s75, s72
s_nop 0
buffer_load_dwordx4 v2, s[20:23], s75 offen lds
s_add_u32 m0, m0, 1024
s_nop 0
buffer_load_dwordx4 v3, s[20:23], s75 offen lds
s_add_u32 m0, m0, 1024
s_nop 0
buffer_load_dwordx4 v4, s[20:23], s75 offen lds
s_add_u32 m0, m0, 1024
s_add_u32 s75, s75, 24576
s_nop 0
buffer_load_dwordx4 v2, s[20:23], s75 offen lds
s_add_u32 m0, m0, 1024
s_nop 0
buffer_load_dwordx4 v3, s[20:23], s75 offen lds
s_add_u32 m0, m0, 1024
s_nop 0
buffer_load_dwordx4 v4, s[20:23], s75 offen lds
s_add_u32 s72, s72, 196608
s_add_u32 s71, s71, 128
s_add_u32 s70, s70, 40960
s_cmp_eq_u32 s70, 122880
s_cselect_b32 s70, 0, s70
s_add_u32 s76, s76, 1
s_cmp_lg_u32 s76, 10
s_cbranch_scc1 L_WRAP_24
s_sub_u32 s71, s71, 1280
s_sub_u32 s72, s72, 1966080
s_mov_b32 s76, 0
L_WRAP_24:
s_add_u32 s74, s74, 1
s_branch L_LDG_LOOP
L_LDG_tail:
s_lshl_b32 s73, s7, 10
s_add_u32 m0, s70, s73
s_mov_b32 s75, s71
buffer_load_dwordx4 v1, s[16:19], s75 offen lds
s_add_u32 m0, m0, 4096
s_add_u32 s75, s75, 40960
buffer_load_dwordx4 v1, s[16:19], s75 offen lds
s_add_u32 m0, m0, 4096
s_add_u32 s75, s75, 40960
buffer_load_dwordx4 v1, s[16:19], s75 offen lds
s_add_u32 m0, m0, 4096
s_add_u32 s75, s75, 40960
buffer_load_dwordx4 v1, s[16:19], s75 offen lds
s_mul_i32 s73, s7, 6144
s_add_u32 s73, s73, 16384
s_add_u32 m0, s70, s73
s_mov_b32 s75, s72
s_nop 0
buffer_load_dwordx4 v2, s[20:23], s75 offen lds
s_add_u32 m0, m0, 1024
s_nop 0
buffer_load_dwordx4 v3, s[20:23], s75 offen lds
s_add_u32 m0, m0, 1024
s_nop 0
buffer_load_dwordx4 v4, s[20:23], s75 offen lds
s_add_u32 m0, m0, 1024
s_add_u32 s75, s75, 24576
s_nop 0
buffer_load_dwordx4 v2, s[20:23], s75 offen lds
s_add_u32 m0, m0, 1024
s_nop 0
buffer_load_dwordx4 v3, s[20:23], s75 offen lds
s_add_u32 m0, m0, 1024
s_nop 0
buffer_load_dwordx4 v4, s[20:23], s75 offen lds
s_add_u32 s72, s72, 196608
s_add_u32 s71, s71, 128
s_add_u32 s70, s70, 40960
s_cmp_eq_u32 s70, 122880
s_cselect_b32 s70, 0, s70
s_add_u32 s76, s76, 1
s_cmp_lg_u32 s76, 10
s_cbranch_scc1 L_WRAP_25
s_sub_u32 s71, s71, 1280
s_sub_u32 s72, s72, 1966080
s_mov_b32 s76, 0
L_WRAP_25:
s_cmp_lg_u32 s7, 3
s_cbranch_scc1 L_LDG_tA
buffer_load_dwordx4 v[44:47], v41, s[12:15], s78 offen sc1
buffer_load_dwordx4 v[48:51], v41, s[12:15], s78 offen offset:1024 sc1
buffer_load_dwordx2 v[52:53], v43, s[12:15], 0 offen sc1
s_waitcnt vmcnt(13)
s_barrier
s_add_u32 s73, s10, 0
s_and_b32 s73, s73, 3
s_lshl_b32 s75, s9, 2
s_add_u32 s73, s73, s75
s_mul_i32 s73, s73, 245760
s_mul_i32 s75, s10, 320
s_add_u32 s73, s73, s75
s_lshl_b32 s75, s7, 10
s_add_u32 m0, s75, 122880
s_nop 0
buffer_load_dwordx4 v5, s[24:27], s73 offen lds
s_add_u32 m0, m0, 4096
s_nop 0
buffer_load_dwordx4 v6, s[24:27], s73 offen lds
s_add_u32 m0, m0, 4096
s_nop 0
buffer_load_dwordx4 v7, s[24:27], s73 offen lds
s_add_u32 m0, m0, 4096
s_nop 0
buffer_load_dwordx4 v8, s[24:27], s73 offen lds
s_add_u32 m0, m0, 4096
s_nop 0
buffer_load_dwordx4 v9, s[24:27], s73 offen lds
s_add_u32 m0, m0, 4096
s_nop 0
buffer_load_dwordx4 v10, s[24:27], s73 offen lds
s_add_u32 m0, m0, 4096
s_nop 0
buffer_load_dwordx4 v11, s[24:27], s73 offen lds
s_add_u32 m0, m0, 4096
s_cmp_ge_u32 s7, 2
s_cbranch_scc1 L_i2skip_G03
s_nop 0
buffer_load_dwordx4 v12, s[24:27], s73 offen lds
L_i2skip_G03:
s_add_u32 s73, s10, 0
s_and_b32 s73, s73, 3
s_lshl_b32 s75, s9, 2
s_add_u32 s73, s73, s75
s_mul_i32 s73, s73, 245760
s_mul_i32 s75, s10, 320
s_add_u32 s73, s73, s75
s_add_u32 s73, s73, 61440
s_lshl_b32 s75, s7, 10
s_add_u32 m0, s75, 0
s_nop 0
buffer_load_dwordx4 v5, s[24:27], s73 offen lds
s_add_u32 m0, m0, 4096
s_nop 0
buffer_load_dwordx4 v6, s[24:27], s73 offen lds
s_add_u32 m0, m0, 4096
s_nop 0
buffer_load_dwordx4 v7, s[24:27], s73 offen lds
s_add_u32 m0, m0, 4096
s_nop 0
buffer_load_dwordx4 v8, s[24:27], s73 offen lds
s_add_u32 m0, m0, 4096
s_nop 0
buffer_load_dwordx4 v9, s[24:27], s73 offen lds
s_add_u32 m0, m0, 4096
s_nop 0
buffer_load_dwordx4 v10, s[24:27], s73 offen lds
s_add_u32 m0, m0, 4096
s_nop 0
buffer_load_dwordx4 v11, s[24:27], s73 offen lds
s_add_u32 m0, m0, 4096
s_cmp_ge_u32 s7, 2
s_cbranch_scc1 L_i2skip_G13
s_nop 0
buffer_load_dwordx4 v12, s[24:27], s73 offen lds
L_i2skip_G13:
s_waitcnt vmcnt(17)
s_barrier
s_add_u32 s73, s10, 1
s_and_b32 s73, s73, 3
s_lshl_b32 s75, s9, 2
s_add_u32 s73, s73, s75
s_mul_i32 s73, s73, 245760
s_mul_i32 s75, s10, 320
s_add_u32 s73, s73, s75
s_lshl_b32 s75, s7, 10
s_add_u32 m0, s75, 30720
s_nop 0
buffer_load_dwordx4 v5, s[24:27], s73 offen lds
s_add_u32 m0, m0, 4096
s_nop 0
buffer_load_dwordx4 v6, s[24:27], s73 offen lds
s_add_u32 m0, m0, 4096
s_nop 0
buffer_load_dwordx4 v7, s[24:27], s73 offen lds
s_add_u32 m0, m0, 4096
s_nop 0
buffer_load_dwordx4 v8, s[24:27], s73 offen lds
s_add_u32 m0, m0, 4096
s_nop 0
buffer_load_dwordx4 v9, s[24:27], s73 offen lds
s_add_u32 m0, m0, 4096
s_nop 0
buffer_load_dwordx4 v10, s[24:27], s73 offen lds
s_add_u32 m0, m0, 4096
s_nop 0
buffer_load_dwordx4 v11, s[24:27], s73 offen lds
s_add_u32 m0, m0, 4096
s_cmp_ge_u32 s7, 2
s_cbranch_scc1 L_i2skip_G23
s_nop 0
buffer_load_dwordx4 v12, s[24:27], s73 offen lds
L_i2skip_G23:
s_waitcnt vmcnt(21)
s_mov_b32 s74, 65536
L_LDG_chk3:
v_xor_b32 v60, s11, v45
v_xor_b32 v61, s11, v47
v_or_b32 v60, v60, v61
v_xor_b32 v61, s11, v49
v_xor_b32 v62, s11, v51
v_or3_b32 v60, v60, v61, v62
v_xor_b32 v61, s11, v53
v_or_b32 v60, v60, v61
v_cmp_ne_u32 vcc, 0, v60
s_cbranch_vccz L_LDG_ok3
s_sub_u32 s74, s74, 1
s_cmp_eq_u32 s74, 0
s_cbranch_scc1 L_LDG_ok3
s_sleep 8
buffer_load_dwordx4 v[44:47], v41, s[12:15], s78 offen sc1
buffer_load_dwordx4 v[48:51], v41, s[12:15], s78 offen offset:1024 sc1
buffer_load_dwordx2 v[52:53], v43, s[12:15], 0 offen sc1
s_waitcnt vmcnt(0)
s_branch L_LDG_chk3
L_LDG_ok3:
v_sub_f32 v60, 0, v44
v_cvt_pk_bf16_f32 v61, v60, v60
v_lshlrev_b32 v63, 16, v61
v_sub_f32 v63, v60, v63
v_cvt_pk_bf16_f32 v62, v63, v63
v_rcp_f32 v64, v46
s_nop 0
v_cvt_pk_bf16_f32 v65, v64, v64
v_lshlrev_b32 v63, 16, v65
v_sub_f32 v63, v64, v63
v_cvt_pk_bf16_f32 v66, v63, v63
s_mov_b32 s76, 0x05040100
v_perm_b32 v68, v62, v61, s76
v_perm_b32 v69, v65, v61, s76
v_and_b32 v70, 0xffff, v66
v_mov_b32 v71, 0
v_lshlrev_b32 v13, 4, v0
v_add_u32 v13, 153600, v13
ds_write_b128 v13, v[68:71]
v_mov_b32 v72, v44
v_mov_b32 v73, v46
v_lshlrev_b32 v13, 3, v0
v_add_u32 v13, 158976, v13
ds_write_b64 v13, v[72:73]
v_lshlrev_b32 v13, 2, v0
v_add_u32 v13, 163200, v13
ds_write_b32 v13, v73
v_sub_f32 v60, 0, v48
v_cvt_pk_bf16_f32 v61, v60, v60
v_lshlrev_b32 v63, 16, v61
v_sub_f32 v63, v60, v63
v_cvt_pk_bf16_f32 v62, v63, v63
v_rcp_f32 v64, v50
s_nop 0
v_cvt_pk_bf16_f32 v65, v64, v64
v_lshlrev_b32 v63, 16, v65
v_sub_f32 v63, v64, v63
v_cvt_pk_bf16_f32 v66, v63, v63
s_mov_b32 s76, 0x05040100
v_perm_b32 v68, v62, v61, s76
v_perm_b32 v69, v65, v61, s76
v_and_b32 v70, 0xffff, v66
v_mov_b32 v71, 0
v_lshlrev_b32 v13, 4, v0
v_add_u32 v13, 154624, v13
ds_write_b128 v13, v[68:71]
v_mov_b32 v72, v48
v_mov_b32 v73, v50
v_lshlrev_b32 v13, 3, v0
v_add_u32 v13, 159488, v13
ds_write_b64 v13, v[72:73]
v_lshlrev_b32 v13, 2, v0
v_add_u32 v13, 163456, v13
ds_write_b32 v13, v73
s_getreg_b32 s73, hwreg(HW_REG_XCC_ID, 0, 4)
v_cmp_ne_u32 vcc, s73, v52
s_cmp_eq_u64 vcc, 0
s_cselect_b32 s73, 1, 0
v_mov_b32 v14, s73
v_mov_b32 v13, 163712
ds_write_b32 v13, v14
s_branch L_LDG_tdone
L_LDG_tA:
s_mov_b32 s79, s78
buffer_load_dwordx2 v[44:45], v41, s[12:15], s79 offen sc1
s_add_u32 s79, s79, 12288
buffer_load_dwordx2 v[46:47], v41, s[12:15], s79 offen sc1
s_add_u32 s79, s79, 12288
buffer_load_dwordx2 v[48:49], v41, s[12:15], s79 offen sc1
s_add_u32 s79, s79, 12288
buffer_load_dwordx2 v[50:51], v41, s[12:15], s79 offen sc1
s_add_u32 s79, s79, 12288
buffer_load_dwordx2 v[52:53], v41, s[12:15], s79 offen sc1
s_add_u32 s79, s79, 12288
buffer_load_dwordx2 v[54:55], v41, s[12:15], s79 offen sc1
s_add_u32 s79, s79, 12288
buffer_load_dwordx2 v[56:57], v41, s[12:15], s79 offen sc1
s_add_u32 s79, s79, 12288
buffer_load_dwordx2 v[58:59], v41, s[12:15], s79 offen sc1
s_add_u32 s79, s79, 12288
buffer_load_dwordx2 v[60:61], v41, s[12:15], s79 offen sc1
s_add_u32 s79, s79, 12288
buffer_load_dwordx2 v[62:63], v41, s[12:15], s79 offen sc1
s_add_u32 s79, s79, 12288
buffer_load_dwordx2 v[64:65], v41, s[12:15], s79 offen sc1
s_add_u32 s79, s79, 12288
buffer_load_dwordx2 v[66:67], v41, s[12:15], s79 offen sc1
s_add_u32 s79, s79, 12288
buffer_load_dwordx2 v[68:69], v41, s[12:15], s79 offen sc1
s_add_u32 s79, s79, 12288
buffer_load_dwordx2 v[70:71], v41, s[12:15], s79 offen sc1
s_add_u32 s79, s79, 12288
buffer_load_dwordx2 v[72:73], v41, s[12:15], s79 offen sc1
s_add_u32 s79, s79, 12288
buffer_load_dwordx2 v[74:75], v41, s[12:15], s79 offen sc1
global_load_ushort v76, v43, s[58:59]
s_waitcnt vmcnt(27)
s_barrier
s_add_u32 s73, s10, 0
s_and_b32 s73, s73, 3
s_lshl_b32 s75, s9, 2
s_add_u32 s73, s73, s75
s_mul_i32 s73, s73, 245760
s_mul_i32 s75, s10, 320
s_add_u32 s73, s73, s75
s_lshl_b32 s75, s7, 10
s_add_u32 m0, s75, 122880
s_nop 0
buffer_load_dwordx4 v5, s[24:27], s73 offen lds
s_add_u32 m0, m0, 4096
s_nop 0
buffer_load_dwordx4 v6, s[24:27], s73 offen lds
s_add_u32 m0, m0, 4096
s_nop 0
buffer_load_dwordx4 v7, s[24:27], s73 offen lds
s_add_u32 m0, m0, 4096
s_nop 0
buffer_load_dwordx4 v8, s[24:27], s73 offen lds
s_add_u32 m0, m0, 4096
s_nop 0
buffer_load_dwordx4 v9, s[24:27], s73 offen lds
s_add_u32 m0, m0, 4096
s_nop 0
buffer_load_dwordx4 v10, s[24:27], s73 offen lds
s_add_u32 m0, m0, 4096
s_nop 0
buffer_load_dwordx4 v11, s[24:27], s73 offen lds
s_add_u32 m0, m0, 4096
s_cmp_ge_u32 s7, 2
s_cbranch_scc1 L_i2skip_G0A
s_nop 0
buffer_load_dwordx4 v12, s[24:27], s73 offen lds
L_i2skip_G0A:
s_add_u32 s73, s10, 0
s_and_b32 s73, s73, 3
s_lshl_b32 s75, s9, 2
s_add_u32 s73, s73, s75
s_mul_i32 s73, s73, 245760
s_mul_i32 s75, s10, 320
s_add_u32 s73, s73, s75
s_add_u32 s73, s73, 61440
s_lshl_b32 s75, s7, 10
s_add_u32 m0, s75, 0
s_nop 0
buffer_load_dwordx4 v5, s[24:27], s73 offen lds
s_add_u32 m0, m0, 4096
s_nop 0
buffer_load_dwordx4 v6, s[24:27], s73 offen lds
s_add_u32 m0, m0, 4096
s_nop 0
buffer_load_dwordx4 v7, s[24:27], s73 offen lds
s_add_u32 m0, m0, 4096
s_nop 0
buffer_load_dwordx4 v8, s[24:27], s73 offen lds
s_add_u32 m0, m0, 4096
s_nop 0
buffer_load_dwordx4 v9, s[24:27], s73 offen lds
s_add_u32 m0, m0, 4096
s_nop 0
buffer_load_dwordx4 v10, s[24:27], s73 offen lds
s_add_u32 m0, m0, 4096
s_nop 0
buffer_load_dwordx4 v11, s[24:27], s73 offen lds
s_add_u32 m0, m0, 4096
s_cmp_ge_u32 s7, 2
s_cbranch_scc1 L_i2skip_G1A
s_nop 0
buffer_load_dwordx4 v12, s[24:27], s73 offen lds
L_i2skip_G1A:
s_waitcnt vmcnt(31)
s_barrier
s_add_u32 s73, s10, 1
s_and_b32 s73, s73, 3
s_lshl_b32 s75, s9, 2
s_add_u32 s73, s73, s75
s_mul_i32 s73, s73, 245760
s_mul_i32 s75, s10, 320
s_add_u32 s73, s73, s75
s_lshl_b32 s75, s7, 10
s_add_u32 m0, s75, 30720
s_nop 0
buffer_load_dwordx4 v5, s[24:27], s73 offen lds
s_add_u32 m0, m0, 4096
s_nop 0
buffer_load_dwordx4 v6, s[24:27], s73 offen lds
s_add_u32 m0, m0, 4096
s_nop 0
buffer_load_dwordx4 v7, s[24:27], s73 offen lds
s_add_u32 m0, m0, 4096
s_nop 0
buffer_load_dwordx4 v8, s[24:27], s73 offen lds
s_add_u32 m0, m0, 4096
s_nop 0
buffer_load_dwordx4 v9, s[24:27], s73 offen lds
s_add_u32 m0, m0, 4096
s_nop 0
buffer_load_dwordx4 v10, s[24:27], s73 offen lds
s_add_u32 m0, m0, 4096
s_nop 0
buffer_load_dwordx4 v11, s[24:27], s73 offen lds
s_add_u32 m0, m0, 4096
s_cmp_ge_u32 s7, 2
s_cbranch_scc1 L_i2skip_G2A
s_nop 0
buffer_load_dwordx4 v12, s[24:27], s73 offen lds
L_i2skip_G2A:
s_waitcnt vmcnt(21)
s_mov_b32 s74, 65536
L_LDG_chkA:
v_xor_b32 v78, s11, v45
v_xor_b32 v79, s11, v47
v_or_b32 v78, v78, v79
v_xor_b32 v79, s11, v49
v_or_b32 v78, v78, v79
v_xor_b32 v79, s11, v51
v_or_b32 v78, v78, v79
v_xor_b32 v79, s11, v53
v_or_b32 v78, v78, v79
v_xor_b32 v79, s11, v55
v_or_b32 v78, v78, v79
v_xor_b32 v79, s11, v57
v_or_b32 v78, v78, v79
v_xor_b32 v79, s11, v59
v_or_b32 v78, v78, v79
v_xor_b32 v79, s11, v61
v_or_b32 v78, v78, v79
v_xor_b32 v79, s11, v63
v_or_b32 v78, v78, v79
v_xor_b32 v79, s11, v65
v_or_b32 v78, v78, v79
v_xor_b32 v79, s11, v67
v_or_b32 v78, v78, v79
v_xor_b32 v79, s11, v69
v_or_b32 v78, v78, v79
v_xor_b32 v79, s11, v71
v_or_b32 v78, v78, v79
v_xor_b32 v79, s11, v73
v_or_b32 v78, v78, v79
v_xor_b32 v79, s11, v75
v_or_b32 v78, v78, v79
v_mov_b32 v77, v78
v_cmp_ne_u32 vcc, 0, v77
s_cbranch_vccz L_LDG_okA
s_sub_u32 s74, s74, 1
s_cmp_eq_u32 s74, 0
s_cbranch_scc1 L_LDG_okA
s_sleep 8
s_mov_b32 s79, s78
buffer_load_dwordx2 v[44:45], v41, s[12:15], s79 offen sc1
s_add_u32 s79, s79, 12288
buffer_load_dwordx2 v[46:47], v41, s[12:15], s79 offen sc1
s_add_u32 s79, s79, 12288
buffer_load_dwordx2 v[48:49], v41, s[12:15], s79 offen sc1
s_add_u32 s79, s79, 12288
buffer_load_dwordx2 v[50:51], v41, s[12:15], s79 offen sc1
s_add_u32 s79, s79, 12288
buffer_load_dwordx2 v[52:53], v41, s[12:15], s79 offen sc1
s_add_u32 s79, s79, 12288
buffer_load_dwordx2 v[54:55], v41, s[12:15], s79 offen sc1
s_add_u32 s79, s79, 12288
buffer_load_dwordx2 v[56:57], v41, s[12:15], s79 offen sc1
s_add_u32 s79, s79, 12288
buffer_load_dwordx2 v[58:59], v41, s[12:15], s79 offen sc1
s_add_u32 s79, s79, 12288
buffer_load_dwordx2 v[60:61], v41, s[12:15], s79 offen sc1
s_add_u32 s79, s79, 12288
buffer_load_dwordx2 v[62:63], v41, s[12:15], s79 offen sc1
s_add_u32 s79, s79, 12288
buffer_load_dwordx2 v[64:65], v41, s[12:15], s79 offen sc1
s_add_u32 s79, s79, 12288
buffer_load_dwordx2 v[66:67], v41, s[12:15], s79 offen sc1
s_add_u32 s79, s79, 12288
buffer_load_dwordx2 v[68:69], v41, s[12:15], s79 offen sc1
s_add_u32 s79, s79, 12288
buffer_load_dwordx2 v[70:71], v41, s[12:15], s79 offen sc1
s_add_u32 s79, s79, 12288
buffer_load_dwordx2 v[72:73], v41, s[12:15], s79 offen sc1
s_add_u32 s79, s79, 12288
buffer_load_dwordx2 v[74:75], v41, s[12:15], s79 offen sc1
global_load_ushort v76, v43, s[58:59]
s_waitcnt vmcnt(0)
s_branch L_LDG_chkA
L_LDG_okA:
v_add_f32 v44, v44, v46
v_add_f32 v44, v44, v48
v_add_f32 v44, v44, v50
v_add_f32 v44, v44, v52
v_add_f32 v44, v44, v54
v_add_f32 v44, v44, v56
v_add_f32 v44, v44, v58
v_add_f32 v44, v44, v60
v_add_f32 v44, v44, v62
v_add_f32 v44, v44, v64
v_add_f32 v44, v44, v66
v_add_f32 v44, v44, v68
v_add_f32 v44, v44, v70
v_add_f32 v44, v44, v72
v_add_f32 v44, v44, v74
v_cvt_pk_bf16_f32 v45, v44, v44
v_lshlrev_b32 v47, 16, v45
v_sub_f32 v47, v44, v47
v_cvt_pk_bf16_f32 v46, v47, v47
s_mov_b32 s76, 0x05040100
v_perm_b32 v48, v45, v45, s76
v_perm_b32 v49, v76, v46, s76
v_and_b32 v50, 0xffff, v76
v_mov_b32 v51, 0
v_lshlrev_b32 v13, 4, v42
v_add_u32 v13, 155904, v13
ds_write_b128 v13, v[48:51]
L_LDG_tdone:
s_waitcnt lgkmcnt(0)
s_barrier
s_add_u32 s73, s10, 1
s_and_b32 s73, s73, 3
s_lshl_b32 s75, s9, 2
s_add_u32 s73, s73, s75
s_mul_i32 s73, s73, 245760
s_mul_i32 s75, s10, 320
s_add_u32 s73, s73, s75
s_add_u32 s73, s73, 61440
s_lshl_b32 s75, s7, 10
s_add_u32 m0, s75, 61440
s_nop 0
buffer_load_dwordx4 v5, s[24:27], s73 offen lds
s_add_u32 m0, m0, 4096
s_nop 0
buffer_load_dwordx4 v6, s[24:27], s73 offen lds
s_add_u32 m0, m0, 4096
s_nop 0
buffer_load_dwordx4 v7, s[24:27], s73 offen lds
s_add_u32 m0, m0, 4096
s_nop 0
buffer_load_dwordx4 v8, s[24:27], s73 offen lds
s_add_u32 m0, m0, 4096
s_nop 0
buffer_load_dwordx4 v9, s[24:27], s73 offen lds
s_add_u32 m0, m0, 4096
s_nop 0
buffer_load_dwordx4 v10, s[24:27], s73 offen lds
s_add_u32 m0, m0, 4096
s_nop 0
buffer_load_dwordx4 v11, s[24:27], s73 offen lds
s_add_u32 m0, m0, 4096
s_cmp_ge_u32 s7, 2
s_cbranch_scc1 L_i2skip_G3
s_nop 0
buffer_load_dwordx4 v12, s[24:27], s73 offen lds
L_i2skip_G3:
s_add_u32 s73, s10, 2
s_and_b32 s73, s73, 3
s_lshl_b32 s75, s9, 2
s_add_u32 s73, s73, s75
s_mul_i32 s73, s73, 245760
s_mul_i32 s75, s10, 320
s_add_u32 s73, s73, s75
s_lshl_b32 s75, s7, 10
s_add_u32 m0, s75, 92160
s_nop 0
buffer_load_dwordx4 v5, s[24:27], s73 offen lds
s_add_u32 m0, m0, 4096
s_nop 0
buffer_load_dwordx4 v6, s[24:27], s73 offen lds
s_add_u32 m0, m0, 4096
s_nop 0
buffer_load_dwordx4 v7, s[24:27], s73 offen lds
s_add_u32 m0, m0, 4096
s_nop 0
buffer_load_dwordx4 v8, s[24:27], s73 offen lds
s_add_u32 m0, m0, 4096
s_nop 0
buffer_load_dwordx4 v9, s[24:27], s73 offen lds
s_add_u32 m0, m0, 4096
s_nop 0
buffer_load_dwordx4 v10, s[24:27], s73 offen lds
s_add_u32 m0, m0, 4096
s_nop 0
buffer_load_dwordx4 v11, s[24:27], s73 offen lds
s_add_u32 m0, m0, 4096
s_cmp_ge_u32 s7, 2
s_cbranch_scc1 L_i2skip_G4
s_nop 0
buffer_load_dwordx4 v12, s[24:27], s73 offen lds
L_i2skip_G4:
s_waitcnt vmcnt(28)
s_barrier
s_waitcnt vmcnt(21)
s_barrier
s_add_u32 s73, s10, 2
s_and_b32 s73, s73, 3
s_lshl_b32 s75, s9, 2
s_add_u32 s73, s73, s75
s_mul_i32 s73, s73, 245760
s_mul_i32 s75, s10, 320
s_add_u32 s73, s73, s75
s_add_u32 s73, s73, 61440
s_lshl_b32 s75, s7, 10
s_add_u32 m0, s75, 122880
s_nop 0
buffer_load_dwordx4 v5, s[24:27], s73 offen lds
s_add_u32 m0, m0, 4096
s_nop 0
buffer_load_dwordx4 v6, s[24:27], s73 offen lds
s_add_u32 m0, m0, 4096
s_nop 0
buffer_load_dwordx4 v7, s[24:27], s73 offen lds
s_add_u32 m0, m0, 4096
s_nop 0
buffer_load_dwordx4 v8, s[24:27], s73 offen lds
s_add_u32 m0, m0, 4096
s_nop 0
buffer_load_dwordx4 v9, s[24:27], s73 offen lds
s_add_u32 m0, m0, 4096
s_nop 0
buffer_load_dwordx4 v10, s[24:27], s73 offen lds
s_add_u32 m0, m0, 4096
s_nop 0
buffer_load_dwordx4 v11, s[24:27], s73 offen lds
s_add_u32 m0, m0, 4096
s_cmp_ge_u32 s7, 2
s_cbranch_scc1 L_i2skip_G5
s_nop 0
buffer_load_dwordx4 v12, s[24:27], s73 offen lds
L_i2skip_G5:
s_waitcnt vmcnt(21)
s_barrier
s_add_u32 s73, s10, 3
s_and_b32 s73, s73, 3
s_lshl_b32 s75, s9, 2
s_add_u32 s73, s73, s75
s_mul_i32 s73, s73, 245760
s_mul_i32 s75, s10, 320
s_add_u32 s73, s73, s75
s_lshl_b32 s75, s7, 10
s_add_u32 m0, s75, 0
s_nop 0
buffer_load_dwordx4 v5, s[24:27], s73 offen lds
s_add_u32 m0, m0, 4096
s_nop 0
buffer_load_dwordx4 v6, s[24:27], s73 offen lds
s_add_u32 m0, m0, 4096
s_nop 0
buffer_load_dwordx4 v7, s[24:27], s73 offen lds
s_add_u32 m0, m0, 4096
s_nop 0
buffer_load_dwordx4 v8, s[24:27], s73 offen lds
s_add_u32 m0, m0, 4096
s_nop 0
buffer_load_dwordx4 v9, s[24:27], s73 offen lds
s_add_u32 m0, m0, 4096
s_nop 0
buffer_load_dwordx4 v10, s[24:27], s73 offen lds
s_add_u32 m0, m0, 4096
s_nop 0
buffer_load_dwordx4 v11, s[24:27], s73 offen lds
s_add_u32 m0, m0, 4096
s_cmp_ge_u32 s7, 2
s_cbranch_scc1 L_i2skip_G6
s_nop 0
buffer_load_dwordx4 v12, s[24:27], s73 offen lds
L_i2skip_G6:
s_waitcnt vmcnt(21)
s_barrier
s_add_u32 s73, s10, 3
s_and_b32 s73, s73, 3
s_lshl_b32 s75, s9, 2
s_add_u32 s73, s73, s75
s_mul_i32 s73, s73, 245760
s_mul_i32 s75, s10, 320
s_add_u32 s73, s73, s75
s_add_u32 s73, s73, 61440
s_lshl_b32 s75, s7, 10
s_add_u32 m0, s75, 30720
s_nop 0
buffer_load_dwordx4 v5, s[24:27], s73 offen lds
s_add_u32 m0, m0, 4096
s_nop 0
buffer_load_dwordx4 v6, s[24:27], s73 offen lds
s_add_u32 m0, m0, 4096
s_nop 0
buffer_load_dwordx4 v7, s[24:27], s73 offen lds
s_add_u32 m0, m0, 4096
s_nop 0
buffer_load_dwordx4 v8, s[24:27], s73 offen lds
s_add_u32 m0, m0, 4096
s_nop 0
buffer_load_dwordx4 v9, s[24:27], s73 offen lds
s_add_u32 m0, m0, 4096
s_nop 0
buffer_load_dwordx4 v10, s[24:27], s73 offen lds
s_add_u32 m0, m0, 4096
s_nop 0
buffer_load_dwordx4 v11, s[24:27], s73 offen lds
s_add_u32 m0, m0, 4096
s_cmp_ge_u32 s7, 2
s_cbranch_scc1 L_i2skip_G7
s_nop 0
buffer_load_dwordx4 v12, s[24:27], s73 offen lds
L_i2skip_G7:
s_waitcnt vmcnt(21)
s_barrier
s_waitcnt vmcnt(14)
s_barrier
s_waitcnt vmcnt(7)
s_barrier
s_waitcnt vmcnt(0)
s_barrier
s_cmp_lg_u32 s2, 0
s_cbranch_scc1 L_LDG_nb
s_cmp_lg_u32 s7, 0
s_cbranch_scc1 L_LDG_nb
v_mov_b32 v13, s11
s_mov_b64 exec, 1
buffer_store_dword v13, off, s[12:15], 0 sc1
s_mov_b64 exec, -1
L_LDG_nb:
s_endpgm
L_END:
s_endpgm
.section .rodata,"a"
.p2align 6
.amdhsa_kernel recurrent_scan__ssm_conv_s5__dense_activation_squared_relu__prompt_kernel
  .amdhsa_next_free_vgpr 168
  .amdhsa_next_free_sgpr 102
  .amdhsa_accum_offset 168
  .amdhsa_group_segment_fixed_size 0
  .amdhsa_kernarg_size 136
  .amdhsa_user_sgpr_count 2
  .amdhsa_user_sgpr_kernarg_segment_ptr 1
  .amdhsa_system_sgpr_workgroup_id_x 1
  .amdhsa_float_denorm_mode_32 3
.end_amdhsa_kernel
```
